```python
import torch

def _softmax(x, axis=-1):
    return torch.softmax(x, dim=axis)
def _gelu(x):
    return torch.nn.functional.gelu(x, approximate="tanh")
def _silu(x):
    return torch.nn.functional.silu(x)
def _sigmoid(x):
    return torch.sigmoid(x)
def _layernorm(x, axis=-1, eps=1e-5):
    m = x.mean(dim=axis, keepdim=True)
    v = x.var(dim=axis, keepdim=True, unbiased=False)
    return (x - m) / torch.sqrt(v + eps)
def _scatter_add(tgt, idx, src, axis=0):
    return tgt.clone().index_add_(axis, idx, src)
def _segment_sum(src, seg, n):
    out = torch.zeros((n,) + src.shape[1:], dtype=src.dtype)
    return out.index_add_(0, seg, src)
def _pad(x, pw):
    flat = tuple(v for pair in reversed(pw) for v in pair)
    return torch.nn.functional.pad(x, flat)

kernel_name = 'gated_mix__gqa_block_cached__geglu_ffn__decode'

def setup_inputs():

    _w = (lambda a: (lambda t: t.to(torch.bfloat16) if t.is_floating_point() else t)(torch.as_tensor(a)))
    def _A_setup():
        B, Sq, D = 8, 1, 512
        Hq, Hkv, Sk, Dh = 32, 8, 8192, 128
        assert Hq % Hkv == 0, (Hq, Hkv)
        return {
            "x": _w((lambda *s: torch.randn(*s, dtype=torch.bfloat16) * 0.05)(B, Sq, D)),
            "k_cache": _w((lambda *s: torch.randn(*s, dtype=torch.bfloat16) * 6.4)(B, Hkv, Sk, Dh)),
            "v_cache": _w((lambda *s: torch.randn(*s, dtype=torch.bfloat16) * 0.2)(B, Hkv, Sk, Dh)),
            "wq": _w((lambda *s: torch.randn(*s, dtype=torch.bfloat16) * 6.4)(D, Hq * Dh) * (D ** -0.5)),
            "wo": _w((lambda *s: torch.randn(*s, dtype=torch.bfloat16) * 0.2)(Hq * Dh, D) * ((Hq * Dh) ** -0.5)),
        }
    _A_in = _A_setup()

    def _B_setup():
        B, S, D, F = 8, 1, 512, 1792
        return {
            "x": _w((lambda *s: torch.randn(*s, dtype=torch.bfloat16) * 0.05)(B, S, D)),
            "w_gate": _w((lambda *s: torch.randn(*s, dtype=torch.bfloat16) * 0.05)(D, F)),
            "w_up": _w((lambda *s: torch.randn(*s, dtype=torch.bfloat16) * 0.05)(D, F)),
            "w_down": _w((lambda *s: torch.randn(*s, dtype=torch.bfloat16) * 0.05)(F, D)),
        }
    _B_in = _B_setup()

    return {
        "A_x": _A_in["x"],
        "A_k_cache": _A_in["k_cache"],
        "A_v_cache": _A_in["v_cache"],
        "A_wq": _A_in["wq"],
        "A_wo": _A_in["wo"],
        "B_x": _B_in["x"],
        "B_w_gate": _B_in["w_gate"],
        "B_w_up": _B_in["w_up"],
        "B_w_down": _B_in["w_down"],
        "gate_w": _w((lambda *s: torch.randn(*s, dtype=torch.bfloat16) * 0.05)(512) * 16.0),
    }

def reference(A_x, A_k_cache, A_v_cache, A_wq, A_wo, B_x, B_w_gate, B_w_up, B_w_down, gate_w):
    def _A_ref(x, k_cache, v_cache, wq, wo):
        B, Sq, D = x.shape
        Hq, Dh = 32, 128
        Hkv = k_cache.shape[1]
        rep = Hq // Hkv
        q = (lambda x, *d: x.permute(*d))((x @ wq).reshape(B, Sq, Hq, Dh), 0, 2, 1, 3)
        k = (lambda x, n, axis: torch.repeat_interleave(x, n, dim=axis))(k_cache, rep, axis=1)
        v = (lambda x, n, axis: torch.repeat_interleave(x, n, dim=axis))(v_cache, rep, axis=1)
        scores = torch.einsum("bhqd,bhkd->bhqk", q, k) * (Dh ** -0.5)
        p = _softmax(scores, axis=-1)
        o = torch.einsum("bhqk,bhkd->bhqd", p, v)
        return (lambda x, *d: x.permute(*d))(o, 0, 2, 1, 3).reshape(B, Sq, Hq * Dh) @ wo

    def _B_ref(x, w_gate, w_up, w_down):
        return (_gelu(x @ w_gate) * (x @ w_up)) @ w_down

    x = A_x
    g = _sigmoid((x * gate_w).sum(-1, keepdims=True))
    a = _A_ref(x, A_k_cache, A_v_cache, A_wq, A_wo)
    b = _B_ref(x, B_w_gate, B_w_up, B_w_down)
    return g * a + (1 - g) * b
```

```asm
; @launch grid=(256,1,1) block=(512,1,1) lds=163840
.amdgcn_target "amdgcn-amd-amdhsa--gfx950"
.text
.globl gated_mix__gqa_block_cached__geglu_ffn__decode_kernel
.p2align 8
.type gated_mix__gqa_block_cached__geglu_ffn__decode_kernel,@function
gated_mix__gqa_block_cached__geglu_ffn__decode_kernel:
    s_cmp_ge_u32 s2, 256
    s_cbranch_scc1 L_end
    s_load_dwordx16 s[32:47], s[0:1], 0
    s_load_dwordx2 s[56:57], s[0:1], 96
    s_load_dwordx8 s[48:55], s[0:1], 64
    s_memrealtime s[96:97]
    v_lshrrev_b32 v1, 6, v0
    v_and_b32 v0, 63, v0
    v_readfirstlane_b32 s3, v1
    s_and_b32 s4, s2, 7
    s_lshr_b32 s6, s2, 5
    s_bfe_u32 s7, s2, 0x20003
    s_lshl3_add_u32 s89, s6, s4
    s_cmp_lt_u32 s3, 4
    s_cbranch_scc1 L_H
    s_sub_u32 s29, s3, 4
    s_lshl_b32 s22, s29, 15
    v_and_b32 v44, 15, v0
    v_lshrrev_b32 v45, 4, v0
    v_add_u32 v46, 0, v45
    v_xor_b32 v46, v44, v46
    v_lshlrev_b32 v46, 4, v46
    v_lshl_add_u32 v2, v45, 8, v46
    v_add_u32 v46, 4, v45
    v_xor_b32 v46, v44, v46
    v_lshlrev_b32 v46, 4, v46
    v_lshl_add_u32 v3, v45, 8, v46
    v_add_u32 v46, 8, v45
    v_xor_b32 v46, v44, v46
    v_lshlrev_b32 v46, 4, v46
    v_lshl_add_u32 v4, v45, 8, v46
    v_add_u32 v46, 12, v45
    v_xor_b32 v46, v44, v46
    v_lshlrev_b32 v46, 4, v46
    v_lshl_add_u32 v5, v45, 8, v46
    s_lshl_b32 s20, s89, 4
    s_and_b32 s24, s89, 15
    s_or_b32 s20, s20, s24
    s_lshl_b32 s20, s20, 17
    s_lshl_b32 s24, s29, 13
    s_or_b32 s20, s20, s24
    s_lshl_b32 s24, s7, 15
    s_or_b32 s20, s20, s24
    s_waitcnt lgkmcnt(0)
    s_mov_b32 s8, s34
    s_and_b32 s9, s35, 0xffff
    s_mov_b32 s10, 0x8000000
    s_mov_b32 s11, 0x20000
    s_add_u32 m0, s22, 24576
    s_xor_b32 s24, s20, 0x0
    buffer_load_dwordx4 v2, s[8:11], s24 offen offset:0 nt lds
    buffer_load_dwordx4 v3, s[8:11], s24 offen offset:1024 nt lds
    buffer_load_dwordx4 v4, s[8:11], s24 offen offset:2048 nt lds
    buffer_load_dwordx4 v5, s[8:11], s24 offen offset:3072 nt lds
    s_load_dword s88, s[56:57], 0
    s_branch L_S2
L_H:
    v_lshrrev_b32 v3, 4, v0
    v_lshrrev_b32 v4, 3, v0
    v_and_b32 v5, 7, v0
    v_lshlrev_b32 v5, 4, v5
    s_cmp_lg_u32 s3, 1
    s_cbranch_scc1 L_Hz
    v_lshl_add_u32 v8, v4, 13, v5
    v_lshlrev_b32 v9, 6, v5
    v_lshl_add_u32 v9, v3, 4, v9
    s_lshl_b32 s58, s7, 20
    s_lshl3_add_u32 s59, s4, s6
    s_lshl_b32 s59, s59, 7
    s_add_u32 s58, s58, s59
    s_lshl_b32 s59, s7, 8
    s_mov_b32 m0, 135168
    s_movk_i32 s20, 15
    s_waitcnt lgkmcnt(0)
    s_mov_b32 s24, s38
    s_and_b32 s25, s39, 0xffff
    s_mov_b32 s26, 0x400000
    s_mov_b32 s27, 0x20000
    s_mov_b32 s28, s32
    s_and_b32 s29, s33, 0xffff
    s_mov_b32 s30, 0x2000
    s_mov_b32 s31, 0x20000
    buffer_load_dwordx4 v[16:19], v9, s[28:31], s59 offen offset:0
    buffer_load_dwordx4 v[20:23], v9, s[28:31], s59 offen offset:64
    buffer_load_dwordx4 v[24:27], v9, s[28:31], s59 offen offset:128
    buffer_load_dwordx4 v[28:31], v9, s[28:31], s59 offen offset:192
L_ql:
    buffer_load_dwordx4 v8, s[24:27], s58 offen nt lds
    s_addk_i32 m0, 1024
    s_add_u32 s58, s58, 65536
    s_sub_u32 s20, s20, 1
    s_cbranch_scc0 L_ql
    s_barrier
    s_branch L_H1
L_Hz:
    v_mov_b32 v24, 0
    v_mov_b32 v25, 0
    v_lshlrev_b32 v26, 3, v0
    v_add_u32 v26, 133120, v26
    ds_write_b64 v26, v[24:25]
    s_cmp_ge_u32 s2, 16
    s_cbranch_scc1 L_noipf
    s_getpc_b64 s[20:21]
L_pc:
    s_min_u32 s22, s3, 1
    s_sub_u32 s22, s3, s22
    s_lshl_b32 s22, s22, 13
    v_lshl_add_u32 v27, v0, 7, s22
    v_add_u32 v28, 0x6000, v27
    v_cmp_gt_u32 vcc, L_end-L_pc, v27
    s_mov_b64 exec, vcc
    global_load_dword v127, v27, s[20:21]
    v_cmp_gt_u32 vcc, L_end-L_pc, v28
    s_mov_b64 exec, vcc
    global_load_dword v127, v28, s[20:21]
    s_mov_b64 exec, -1
L_noipf:
    s_waitcnt lgkmcnt(0)
    s_barrier
    s_branch L_Hx
L_S2:
    s_barrier
    s_mov_b32 s60, s96
    s_mov_b32 s45, 0
    v_mov_b32 v32, 133424
    v_mov_b32 v34, 0
    s_mov_b32 s50, 672
    v_mov_b32 v35, 0xffffff80
    s_mov_b32 s58, 1600
    s_lshr_b32 s42, s2, 3
    s_lshl2_add_u32 s42, s42, s29
    s_mul_i32 s42, s42, 0x9e3779b1
    s_mul_i32 s43, s4, 0x61c88647
    s_lshr_b32 s43, s43, 3
    s_add_u32 s42, s42, s43
    s_lshr_b32 s42, s42, 26
    s_mul_i32 s42, s42, 866
    s_lshr_b32 s42, s42, 6
    s_sub_u32 s42, s42, 433
    s_add_u32 s58, s58, s42
    v_add_u32 v46, 0, v45
    v_lshlrev_b32 v46, 1, v46
    v_xor_b32 v46, v44, v46
    v_lshlrev_b32 v46, 4, v46
    v_lshl_add_u32 v122, v45, 8, v46
    v_add_u32 v46, 4, v45
    v_lshlrev_b32 v46, 1, v46
    v_xor_b32 v46, v44, v46
    v_lshlrev_b32 v46, 4, v46
    v_lshl_add_u32 v123, v45, 8, v46
    s_mov_b32 s16, s56
    s_and_b32 s17, s57, 0xffff
    s_mov_b32 s18, 0x1000000
    s_mov_b32 s19, 0x20000
    v_add_u32 v46, 0, v45
    v_xor_b32 v46, v44, v46
    v_lshlrev_b32 v46, 4, v46
    v_lshl_add_u32 v46, v44, 8, v46
    v_add_u32 v8, s22, v46
    v_add_u32 v46, 4, v45
    v_xor_b32 v46, v44, v46
    v_lshlrev_b32 v46, 4, v46
    v_lshl_add_u32 v46, v44, 8, v46
    v_add_u32 v9, s22, v46
    v_add_u32 v46, 8, v45
    v_xor_b32 v46, v44, v46
    v_lshlrev_b32 v46, 4, v46
    v_lshl_add_u32 v46, v44, 8, v46
    v_add_u32 v10, s22, v46
    v_add_u32 v46, 12, v45
    v_xor_b32 v46, v44, v46
    v_lshlrev_b32 v46, 4, v46
    v_lshl_add_u32 v46, v44, 8, v46
    v_add_u32 v11, s22, v46
    v_lshrrev_b32 v46, 2, v0
    v_and_b32 v47, 7, v46
    v_lshlrev_b32 v46, 8, v46
    v_and_b32 v43, 3, v0
    v_lshl_add_u32 v46, v43, 3, v46
    s_add_u32 s24, s22, 8192
    v_add_u32 v46, s24, v46
    v_xor_b32 v43, 0, v47
    v_lshl_add_u32 v12, v43, 5, v46
    v_xor_b32 v43, 1, v47
    v_lshl_add_u32 v13, v43, 5, v46
    v_xor_b32 v43, 2, v47
    v_lshl_add_u32 v14, v43, 5, v46
    v_xor_b32 v43, 3, v47
    v_lshl_add_u32 v15, v43, 5, v46
    v_xor_b32 v43, 4, v47
    v_lshl_add_u32 v16, v43, 5, v46
    v_xor_b32 v43, 5, v47
    v_lshl_add_u32 v17, v43, 5, v46
    v_xor_b32 v43, 6, v47
    v_lshl_add_u32 v18, v43, 5, v46
    v_xor_b32 v43, 7, v47
    v_lshl_add_u32 v19, v43, 5, v46
    v_and_b32 v43, 3, v0
    v_lshlrev_b32 v43, 8, v43
    v_lshl_add_u32 v43, v45, 4, v43
    v_add_u32 v43, 131072, v43
    v_bfe_u32 v42, v0, 2, 1
    v_mov_b32 v41, 133120
    v_mov_b32 v21, 0xf149f2ca
    v_cmp_eq_u32 vcc, 0, v42
    s_nop 1
    v_cndmask_b32 v36, v41, v43, vcc
    v_cmp_eq_u32 vcc, 1, v42
    s_nop 1
    v_cndmask_b32 v37, v41, v43, vcc
    v_mov_b32 v80, 0
    v_mov_b32 v81, 0
    v_mov_b32 v82, 0
    v_mov_b32 v83, 0
    v_mov_b32 v84, 0
    v_mov_b32 v85, 0
    v_mov_b32 v86, 0
    v_mov_b32 v87, 0
    v_mov_b32 v88, 0
    v_mov_b32 v89, 0
    v_mov_b32 v90, 0
    v_mov_b32 v91, 0
    v_mov_b32 v92, 0
    v_mov_b32 v93, 0
    v_mov_b32 v94, 0
    v_mov_b32 v95, 0
    v_mov_b32 v96, 0
    v_mov_b32 v97, 0
    v_mov_b32 v98, 0
    v_mov_b32 v99, 0
    v_mov_b32 v100, 0
    v_mov_b32 v101, 0
    v_mov_b32 v102, 0
    v_mov_b32 v103, 0
    v_mov_b32 v104, 0
    v_mov_b32 v105, 0
    v_mov_b32 v106, 0
    v_mov_b32 v107, 0
    v_mov_b32 v108, 0
    v_mov_b32 v109, 0
    v_mov_b32 v110, 0
    v_mov_b32 v111, 0
    v_mul_u32_u24 v46, 0x240, v44
    v_lshl_add_u32 v46, v45, 4, v46
    s_add_u32 s24, s22, 28672
    v_add_u32 v116, s24, v46
    s_lshl_b32 s24, s29, 4
    s_add_u32 s24, s24, 133440
    v_lshl_add_u32 v118, v0, 2, s24
    v_cmp_gt_u32 s[38:39], 4, v44
    v_lshl_add_u32 v119, v0, 4, s22
    v_and_b32 v46, 7, v0
    v_lshl_add_u32 v46, v45, 3, v46
    s_add_u32 s24, s22, 24576
    v_lshl_add_u32 v6, v46, 3, s24
    v_mov_b32 v7, v6
    s_mov_b32 s26, 0x3fb8aa3b
    s_mov_b32 s27, 0x3db504f3
    s_mov_b32 s25, 0
    s_add_u32 s62, s22, 16384
    s_movk_i32 s63, 8192
    v_mov_b32 v112, 0
    v_mov_b32 v113, 0
    v_mov_b32 v114, 0
    v_mov_b32 v115, 0
    s_mov_b32 s92, 0x7060500
    s_mov_b32 s93, 0x7060501
    s_mov_b32 s94, 0x7060502
    s_mov_b32 s95, 0x7060503
    s_mov_b32 s64, 0x0c0c0400
    s_mov_b32 s65, 0x04000c0c
    v_mov_b32 v47, 133400
    s_add_u32 s58, s58, 890
    s_add_u32 s59, s58, s45
    s_lshr_b32 s59, s59, 4
    s_add_u32 s59, s59, s60
L_pc0:
    s_memrealtime s[90:91]
    s_waitcnt lgkmcnt(0)
    s_sub_u32 s90, s90, s59
    s_cmp_lt_i32 s90, 0
    s_cbranch_scc1 L_pc0
L_pg0:
    s_add_u32 m0, s22, 28672
    s_xor_b32 s24, s20, 0x1000
    buffer_load_dwordx4 v2, s[8:11], s24 offen offset:0 nt lds
    buffer_load_dwordx4 v3, s[8:11], s24 offen offset:1024 nt lds
    buffer_load_dwordx4 v4, s[8:11], s24 offen offset:2048 nt lds
    buffer_load_dwordx4 v5, s[8:11], s24 offen offset:3072 nt lds
    s_cmp_ge_u32 s4, 4
    s_cselect_b32 s24, 24, 0
    s_sub_u32 s60, s60, s24
    s_add_u32 s58, s58, 2290
    s_add_u32 s59, s58, s45
    s_lshr_b32 s59, s59, 4
    s_add_u32 s59, s59, s60
L_pc1:
    s_memrealtime s[90:91]
    s_waitcnt lgkmcnt(0)
    s_sub_u32 s90, s90, s59
    s_cmp_lt_i32 s90, 0
    s_cbranch_scc1 L_pc1
L_pg1:
    s_add_u32 m0, s22, 0
    s_xor_b32 s24, s20, 0x20000
    buffer_load_dwordx4 v2, s[8:11], s24 offen offset:0 nt lds
    buffer_load_dwordx4 v3, s[8:11], s24 offen offset:1024 nt lds
    buffer_load_dwordx4 v4, s[8:11], s24 offen offset:2048 nt lds
    buffer_load_dwordx4 v5, s[8:11], s24 offen offset:3072 nt lds
    s_add_u32 s58, s58, 890
    s_add_u32 s59, s58, s45
    s_lshr_b32 s59, s59, 4
    s_add_u32 s59, s59, s60
L_pc2:
    s_memrealtime s[90:91]
    s_waitcnt lgkmcnt(0)
    s_sub_u32 s90, s90, s59
    s_cmp_lt_i32 s90, 0
    s_cbranch_scc1 L_pc2
L_pg2:
    s_add_u32 m0, s22, 4096
    s_xor_b32 s24, s20, 0x21000
    buffer_load_dwordx4 v2, s[8:11], s24 offen offset:0 nt lds
    buffer_load_dwordx4 v3, s[8:11], s24 offen offset:1024 nt lds
    buffer_load_dwordx4 v4, s[8:11], s24 offen offset:2048 nt lds
    buffer_load_dwordx4 v5, s[8:11], s24 offen offset:3072 nt lds
    s_waitcnt vmcnt(12)
    s_add_u32 s58, s58, 890
    s_add_u32 s59, s58, s45
    s_lshr_b32 s59, s59, 4
    s_add_u32 s59, s59, s60
L_pc3:
    s_memrealtime s[90:91]
    s_waitcnt lgkmcnt(0)
    s_sub_u32 s90, s90, s59
    s_cmp_lt_i32 s90, 0
    s_cbranch_scc1 L_pc3
L_pg3:
    s_add_u32 m0, s22, 8192
    s_xor_b32 s24, s20, 0x40000
    buffer_load_dwordx4 v2, s[8:11], s24 offen offset:0 nt lds
    buffer_load_dwordx4 v3, s[8:11], s24 offen offset:1024 nt lds
    buffer_load_dwordx4 v4, s[8:11], s24 offen offset:2048 nt lds
    buffer_load_dwordx4 v5, s[8:11], s24 offen offset:3072 nt lds
    s_waitcnt vmcnt(12)
    s_add_u32 s58, s58, 890
    s_add_u32 s59, s58, s45
    s_lshr_b32 s59, s59, 4
    s_add_u32 s59, s59, s60
L_pc4:
    s_memrealtime s[90:91]
    s_waitcnt lgkmcnt(0)
    s_sub_u32 s90, s90, s59
    s_cmp_lt_i32 s90, 0
    s_cbranch_scc1 L_pc4
L_pg4:
    s_add_u32 m0, s22, 12288
    s_xor_b32 s24, s20, 0x41000
    buffer_load_dwordx4 v2, s[8:11], s24 offen offset:0 nt lds
    buffer_load_dwordx4 v3, s[8:11], s24 offen offset:1024 nt lds
    buffer_load_dwordx4 v4, s[8:11], s24 offen offset:2048 nt lds
    buffer_load_dwordx4 v5, s[8:11], s24 offen offset:3072 nt lds
    s_waitcnt vmcnt(12)
    s_add_u32 s58, s58, 890
    s_add_u32 s59, s58, s45
    s_lshr_b32 s59, s59, 4
    s_add_u32 s59, s59, s60
L_pc5:
    s_memrealtime s[90:91]
    s_waitcnt lgkmcnt(0)
    s_sub_u32 s90, s90, s59
    s_cmp_lt_i32 s90, 0
    s_cbranch_scc1 L_pc5
L_pg5:
    s_add_u32 m0, s22, 16384
    s_xor_b32 s24, s20, 0x60000
    buffer_load_dwordx4 v2, s[8:11], s24 offen offset:0 nt lds
    buffer_load_dwordx4 v3, s[8:11], s24 offen offset:1024 nt lds
    buffer_load_dwordx4 v4, s[8:11], s24 offen offset:2048 nt lds
    buffer_load_dwordx4 v5, s[8:11], s24 offen offset:3072 nt lds
    s_waitcnt vmcnt(12)
    s_add_u32 s58, s58, 890
    s_add_u32 s59, s58, s45
    s_lshr_b32 s59, s59, 4
    s_add_u32 s59, s59, s60
L_pc6:
    s_memrealtime s[90:91]
    s_waitcnt lgkmcnt(0)
    s_sub_u32 s90, s90, s59
    s_cmp_lt_i32 s90, 0
    s_cbranch_scc1 L_pc6
L_pg6:
    s_add_u32 m0, s22, 20480
    s_xor_b32 s24, s20, 0x61000
    buffer_load_dwordx4 v2, s[8:11], s24 offen offset:0 nt lds
    buffer_load_dwordx4 v3, s[8:11], s24 offen offset:1024 nt lds
    buffer_load_dwordx4 v4, s[8:11], s24 offen offset:2048 nt lds
    buffer_load_dwordx4 v5, s[8:11], s24 offen offset:3072 nt lds
    s_waitcnt vmcnt(12)
    s_add_u32 s58, s58, 890
    s_add_u32 s59, s58, s45
    s_lshr_b32 s59, s59, 4
    s_add_u32 s59, s59, s60
L_pc7:
    s_memrealtime s[90:91]
    s_waitcnt lgkmcnt(0)
    s_sub_u32 s90, s90, s59
    s_cmp_lt_i32 s90, 0
    s_cbranch_scc1 L_pc7
L_pg7:
    s_xor_b32 s24, s20, 0x80000
    buffer_load_dwordx4 a[64:67], v2, s[8:11], s24 offen offset:0 nt
    buffer_load_dwordx4 a[68:71], v3, s[8:11], s24 offen offset:1024 nt
    buffer_load_dwordx4 a[72:75], v4, s[8:11], s24 offen offset:2048 nt
    buffer_load_dwordx4 a[76:79], v5, s[8:11], s24 offen offset:3072 nt
    s_waitcnt vmcnt(12)
    s_add_u32 s58, s58, 890
    s_add_u32 s59, s58, s45
    s_lshr_b32 s59, s59, 4
    s_add_u32 s59, s59, s60
L_pc8:
    s_memrealtime s[90:91]
    s_waitcnt lgkmcnt(0)
    s_sub_u32 s90, s90, s59
    s_cmp_lt_i32 s90, 0
    s_cbranch_scc1 L_pc8
L_pg8:
    s_xor_b32 s24, s20, 0x81000
    buffer_load_dwordx4 a[80:83], v2, s[8:11], s24 offen offset:0 nt
    buffer_load_dwordx4 a[84:87], v3, s[8:11], s24 offen offset:1024 nt
    buffer_load_dwordx4 a[88:91], v4, s[8:11], s24 offen offset:2048 nt
    buffer_load_dwordx4 a[92:95], v5, s[8:11], s24 offen offset:3072 nt
    s_waitcnt vmcnt(12)
    s_add_u32 s58, s58, 890
    s_add_u32 s59, s58, s45
    s_lshr_b32 s59, s59, 4
    s_add_u32 s59, s59, s60
L_pc9:
    s_memrealtime s[90:91]
    s_waitcnt lgkmcnt(0)
    s_sub_u32 s90, s90, s59
    s_cmp_lt_i32 s90, 0
    s_cbranch_scc1 L_pc9
L_pg9:
    s_xor_b32 s24, s20, 0xa0000
    buffer_load_dwordx4 a[96:99], v2, s[8:11], s24 offen offset:0 nt
    buffer_load_dwordx4 a[100:103], v3, s[8:11], s24 offen offset:1024 nt
    buffer_load_dwordx4 a[104:107], v4, s[8:11], s24 offen offset:2048 nt
    buffer_load_dwordx4 a[108:111], v5, s[8:11], s24 offen offset:3072 nt
    s_waitcnt vmcnt(12)
    s_add_u32 s58, s58, 890
    s_add_u32 s59, s58, s45
    s_lshr_b32 s59, s59, 4
    s_add_u32 s59, s59, s60
L_pc10:
    s_memrealtime s[90:91]
    s_waitcnt lgkmcnt(0)
    s_sub_u32 s90, s90, s59
    s_cmp_lt_i32 s90, 0
    s_cbranch_scc1 L_pc10
L_pg10:
    s_xor_b32 s24, s20, 0xa1000
    buffer_load_dwordx4 a[112:115], v2, s[8:11], s24 offen offset:0 nt
    buffer_load_dwordx4 a[116:119], v3, s[8:11], s24 offen offset:1024 nt
    buffer_load_dwordx4 a[120:123], v4, s[8:11], s24 offen offset:2048 nt
    buffer_load_dwordx4 a[124:127], v5, s[8:11], s24 offen offset:3072 nt
    s_add_u32 s88, s88, 0x1010101
    v_mov_b32 v126, s88
    s_mov_b32 s70, 0x100000
L_wq:
    ds_read_b32 v46, v47 offset:0
    s_sub_u32 s70, s70, 1
    s_waitcnt lgkmcnt(0)
    v_cmp_ne_u32 vcc, 1, v46
    s_cbranch_vccz L_wqok
    s_sleep 1
    s_cmp_lg_u32 s70, 0
    s_cbranch_scc1 L_wq
L_wqok:
    ds_read_b128 a[0:3], v36 offset:0
    ds_read_b128 a[4:7], v36 offset:64
    ds_read_b128 a[8:11], v36 offset:128
    ds_read_b128 a[12:15], v36 offset:192
    ds_read_b128 a[16:19], v37 offset:0
    ds_read_b128 a[20:23], v37 offset:64
    ds_read_b128 a[24:27], v37 offset:128
    ds_read_b128 a[28:31], v37 offset:192
    ds_read_b32 v46, v47 offset:4
    s_add_u32 s58, s58, 0
    s_waitcnt vmcnt(16) lgkmcnt(0)
    v_readfirstlane_b32 s42, v46
    s_sub_u32 s42, s42, s60
    s_min_i32 s42, s42, 200
    s_max_i32 s42, s42, -200
    s_lshl_b32 s43, s42, 4
    s_mul_i32 s42, s42, 79
    s_ashr_i32 s42, s42, 8
    s_mul_i32 s44, s42, 52
    s_sub_u32 s43, s43, s44
    s_add_u32 s58, s58, s43
    s_min_i32 s42, s42, 64
    s_max_i32 s42, s42, -64
    s_add_u32 s43, s42, 866
    s_add_u32 s42, s42, 866
    ds_read_b128 v[48:51], v8 offset:24576
    ds_read_b128 v[52:55], v9 offset:24576
    ds_read_b128 v[56:59], v10 offset:24576
    ds_read_b128 v[60:63], v11 offset:24576
    ds_read_b128 v[64:67], v8 offset:28672
    ds_read_b128 v[68:71], v9 offset:28672
    ds_read_b128 v[72:75], v10 offset:28672
    ds_read_b128 v[76:79], v11 offset:28672
    s_waitcnt lgkmcnt(4)
    v_mfma_f32_16x16x32_bf16 v[24:27], v[48:51], a[0:3], 0
    v_mfma_f32_16x16x32_bf16 v[24:27], v[52:55], a[4:7], v[24:27]
    v_mfma_f32_16x16x32_bf16 v[24:27], v[56:59], a[8:11], v[24:27]
    v_mfma_f32_16x16x32_bf16 v[24:27], v[60:63], a[12:15], v[24:27]
    s_waitcnt lgkmcnt(0)
    v_mfma_f32_16x16x32_bf16 v[24:27], v[64:67], a[16:19], v[24:27]
    v_mfma_f32_16x16x32_bf16 v[24:27], v[68:71], a[20:23], v[24:27]
    v_mfma_f32_16x16x32_bf16 v[24:27], v[72:75], a[24:27], v[24:27]
    v_mfma_f32_16x16x32_bf16 v[24:27], v[76:79], a[28:31], v[24:27]
    s_nop 7
    s_nop 3
    v_cvt_pk_bf16_f32 v40, v24, v25
    v_cvt_pk_bf16_f32 v41, v26, v27
    v_lshlrev_b32 v36, 16, v40
    v_and_b32 v37, 0xffff0000, v40
    v_lshlrev_b32 v38, 16, v41
    v_and_b32 v39, 0xffff0000, v41
    v_mul_f32 v36, s27, v36
    v_mul_f32 v37, s27, v37
    v_mul_f32 v38, s27, v38
    v_mul_f32 v39, s27, v39
    v_cvt_pk_bf16_f32 v40, v36, v37
    v_cvt_pk_bf16_f32 v41, v38, v39
    v_max3_f32 v21, v36, v37, v21
    ds_write_b64 v6, v[40:41] offset:0
    v_max3_f32 v21, v38, v39, v21
    ds_read_b128 v[48:51], v8 offset:0
    ds_read_b128 v[52:55], v9 offset:0
    ds_read_b128 v[56:59], v10 offset:0
    ds_read_b128 v[60:63], v11 offset:0
    ds_read_b128 v[64:67], v8 offset:4096
    ds_read_b128 v[68:71], v9 offset:4096
    ds_read_b128 v[72:75], v10 offset:4096
    ds_read_b128 v[76:79], v11 offset:4096
    s_waitcnt lgkmcnt(4)
    v_mfma_f32_16x16x32_bf16 v[24:27], v[48:51], a[0:3], 0
    v_mfma_f32_16x16x32_bf16 v[24:27], v[52:55], a[4:7], v[24:27]
    v_mfma_f32_16x16x32_bf16 v[24:27], v[56:59], a[8:11], v[24:27]
    v_mfma_f32_16x16x32_bf16 v[24:27], v[60:63], a[12:15], v[24:27]
    s_waitcnt lgkmcnt(0)
    v_mfma_f32_16x16x32_bf16 v[24:27], v[64:67], a[16:19], v[24:27]
    v_mfma_f32_16x16x32_bf16 v[24:27], v[68:71], a[20:23], v[24:27]
    v_mfma_f32_16x16x32_bf16 v[24:27], v[72:75], a[24:27], v[24:27]
    v_mfma_f32_16x16x32_bf16 v[24:27], v[76:79], a[28:31], v[24:27]
    s_add_u32 s58, s58, s42
    s_add_u32 s59, s58, s45
    s_lshr_b32 s59, s59, 4
    s_add_u32 s59, s59, s60
L_pc11:
    s_memrealtime s[90:91]
    s_waitcnt lgkmcnt(0)
    s_sub_u32 s90, s90, s59
    s_cmp_lt_i32 s90, 0
    s_cbranch_scc1 L_pc11
L_pg11:
    s_add_u32 m0, s22, 0
    s_xor_b32 s24, s20, 0xc0000
    buffer_load_dwordx4 v2, s[8:11], s24 offen offset:0 nt lds
    buffer_load_dwordx4 v3, s[8:11], s24 offen offset:1024 nt lds
    buffer_load_dwordx4 v4, s[8:11], s24 offen offset:2048 nt lds
    buffer_load_dwordx4 v5, s[8:11], s24 offen offset:3072 nt lds
    v_cvt_pk_bf16_f32 v40, v24, v25
    v_cvt_pk_bf16_f32 v41, v26, v27
    v_lshlrev_b32 v36, 16, v40
    v_and_b32 v37, 0xffff0000, v40
    v_lshlrev_b32 v38, 16, v41
    v_and_b32 v39, 0xffff0000, v41
    v_mul_f32 v36, s27, v36
    v_mul_f32 v37, s27, v37
    v_mul_f32 v38, s27, v38
    v_mul_f32 v39, s27, v39
    v_cvt_pk_bf16_f32 v40, v36, v37
    v_cvt_pk_bf16_f32 v41, v38, v39
    v_max3_f32 v21, v36, v37, v21
    ds_write_b64 v6, v[40:41] offset:256
    v_max3_f32 v21, v38, v39, v21
    ds_read_b128 v[48:51], v8 offset:8192
    ds_read_b128 v[52:55], v9 offset:8192
    ds_read_b128 v[56:59], v10 offset:8192
    ds_read_b128 v[60:63], v11 offset:8192
    ds_read_b128 v[64:67], v8 offset:12288
    ds_read_b128 v[68:71], v9 offset:12288
    ds_read_b128 v[72:75], v10 offset:12288
    ds_read_b128 v[76:79], v11 offset:12288
    s_waitcnt lgkmcnt(4)
    v_mfma_f32_16x16x32_bf16 v[24:27], v[48:51], a[0:3], 0
    v_mfma_f32_16x16x32_bf16 v[24:27], v[52:55], a[4:7], v[24:27]
    v_mfma_f32_16x16x32_bf16 v[24:27], v[56:59], a[8:11], v[24:27]
    v_mfma_f32_16x16x32_bf16 v[24:27], v[60:63], a[12:15], v[24:27]
    s_waitcnt lgkmcnt(0)
    v_mfma_f32_16x16x32_bf16 v[24:27], v[64:67], a[16:19], v[24:27]
    v_mfma_f32_16x16x32_bf16 v[24:27], v[68:71], a[20:23], v[24:27]
    v_mfma_f32_16x16x32_bf16 v[24:27], v[72:75], a[24:27], v[24:27]
    v_mfma_f32_16x16x32_bf16 v[24:27], v[76:79], a[28:31], v[24:27]
    s_add_u32 s58, s58, s42
    s_add_u32 s59, s58, s45
    s_lshr_b32 s59, s59, 4
    s_add_u32 s59, s59, s60
L_pc12:
    s_memrealtime s[90:91]
    s_waitcnt lgkmcnt(0)
    s_sub_u32 s90, s90, s59
    s_cmp_lt_i32 s90, 0
    s_cbranch_scc1 L_pc12
L_pg12:
    s_add_u32 m0, s22, 4096
    s_xor_b32 s24, s20, 0xc1000
    buffer_load_dwordx4 v2, s[8:11], s24 offen offset:0 nt lds
    buffer_load_dwordx4 v3, s[8:11], s24 offen offset:1024 nt lds
    buffer_load_dwordx4 v4, s[8:11], s24 offen offset:2048 nt lds
    buffer_load_dwordx4 v5, s[8:11], s24 offen offset:3072 nt lds
    v_cvt_pk_bf16_f32 v40, v24, v25
    v_cvt_pk_bf16_f32 v41, v26, v27
    v_lshlrev_b32 v36, 16, v40
    v_and_b32 v37, 0xffff0000, v40
    v_lshlrev_b32 v38, 16, v41
    v_and_b32 v39, 0xffff0000, v41
    v_mul_f32 v36, s27, v36
    v_mul_f32 v37, s27, v37
    v_mul_f32 v38, s27, v38
    v_mul_f32 v39, s27, v39
    v_cvt_pk_bf16_f32 v40, v36, v37
    v_cvt_pk_bf16_f32 v41, v38, v39
    v_max3_f32 v21, v36, v37, v21
    ds_write_b64 v6, v[40:41] offset:512
    v_max3_f32 v21, v38, v39, v21
    ds_read_b128 v[48:51], v8 offset:16384
    ds_read_b128 v[52:55], v9 offset:16384
    ds_read_b128 v[56:59], v10 offset:16384
    ds_read_b128 v[60:63], v11 offset:16384
    ds_read_b128 v[64:67], v8 offset:20480
    ds_read_b128 v[68:71], v9 offset:20480
    ds_read_b128 v[72:75], v10 offset:20480
    ds_read_b128 v[76:79], v11 offset:20480
    s_waitcnt lgkmcnt(4)
    v_mfma_f32_16x16x32_bf16 v[24:27], v[48:51], a[0:3], 0
    v_mfma_f32_16x16x32_bf16 v[24:27], v[52:55], a[4:7], v[24:27]
    v_mfma_f32_16x16x32_bf16 v[24:27], v[56:59], a[8:11], v[24:27]
    v_mfma_f32_16x16x32_bf16 v[24:27], v[60:63], a[12:15], v[24:27]
    s_waitcnt lgkmcnt(0)
    v_mfma_f32_16x16x32_bf16 v[24:27], v[64:67], a[16:19], v[24:27]
    v_mfma_f32_16x16x32_bf16 v[24:27], v[68:71], a[20:23], v[24:27]
    v_mfma_f32_16x16x32_bf16 v[24:27], v[72:75], a[24:27], v[24:27]
    v_mfma_f32_16x16x32_bf16 v[24:27], v[76:79], a[28:31], v[24:27]
    s_add_u32 s58, s58, s42
    s_add_u32 s59, s58, s45
    s_lshr_b32 s59, s59, 4
    s_add_u32 s59, s59, s60
L_pc13:
    s_memrealtime s[90:91]
    s_waitcnt lgkmcnt(0)
    s_sub_u32 s90, s90, s59
    s_cmp_lt_i32 s90, 0
    s_cbranch_scc1 L_pc13
L_pg13:
    s_add_u32 m0, s22, 8192
    s_xor_b32 s24, s20, 0xe0000
    buffer_load_dwordx4 v2, s[8:11], s24 offen offset:0 nt lds
    buffer_load_dwordx4 v3, s[8:11], s24 offen offset:1024 nt lds
    buffer_load_dwordx4 v4, s[8:11], s24 offen offset:2048 nt lds
    buffer_load_dwordx4 v5, s[8:11], s24 offen offset:3072 nt lds
    v_cvt_pk_bf16_f32 v40, v24, v25
    v_cvt_pk_bf16_f32 v41, v26, v27
    v_lshlrev_b32 v36, 16, v40
    v_and_b32 v37, 0xffff0000, v40
    v_lshlrev_b32 v38, 16, v41
    v_and_b32 v39, 0xffff0000, v41
    v_mul_f32 v36, s27, v36
    v_mul_f32 v37, s27, v37
    v_mul_f32 v38, s27, v38
    v_mul_f32 v39, s27, v39
    v_cvt_pk_bf16_f32 v40, v36, v37
    v_cvt_pk_bf16_f32 v41, v38, v39
    v_max3_f32 v21, v36, v37, v21
    ds_write_b64 v6, v[40:41] offset:768
    v_max3_f32 v21, v38, v39, v21
    s_waitcnt vmcnt(20)
    ds_write_b128 v119, a[64:67] offset:28672
    ds_write_b128 v119, a[68:71] offset:29696
    ds_write_b128 v119, a[72:75] offset:30720
    ds_write_b128 v119, a[76:79] offset:31744
    ds_read_b128 v[48:51], v8 offset:28672
    ds_read_b128 v[52:55], v9 offset:28672
    ds_read_b128 v[56:59], v10 offset:28672
    ds_read_b128 v[60:63], v11 offset:28672
    ds_write_b128 v119, a[80:83] offset:28672
    ds_write_b128 v119, a[84:87] offset:29696
    ds_write_b128 v119, a[88:91] offset:30720
    ds_write_b128 v119, a[92:95] offset:31744
    ds_read_b128 v[64:67], v8 offset:28672
    ds_read_b128 v[68:71], v9 offset:28672
    ds_read_b128 v[72:75], v10 offset:28672
    ds_read_b128 v[76:79], v11 offset:28672
    s_waitcnt lgkmcnt(8)
    v_mfma_f32_16x16x32_bf16 v[24:27], v[48:51], a[0:3], 0
    v_mfma_f32_16x16x32_bf16 v[24:27], v[52:55], a[4:7], v[24:27]
    v_mfma_f32_16x16x32_bf16 v[24:27], v[56:59], a[8:11], v[24:27]
    v_mfma_f32_16x16x32_bf16 v[24:27], v[60:63], a[12:15], v[24:27]
    s_waitcnt lgkmcnt(0)
    v_mfma_f32_16x16x32_bf16 v[24:27], v[64:67], a[16:19], v[24:27]
    v_mfma_f32_16x16x32_bf16 v[24:27], v[68:71], a[20:23], v[24:27]
    v_mfma_f32_16x16x32_bf16 v[24:27], v[72:75], a[24:27], v[24:27]
    v_mfma_f32_16x16x32_bf16 v[24:27], v[76:79], a[28:31], v[24:27]
    s_add_u32 s58, s58, s42
    s_add_u32 s59, s58, s45
    s_lshr_b32 s59, s59, 4
    s_add_u32 s59, s59, s60
L_pc14:
    s_memrealtime s[90:91]
    s_waitcnt lgkmcnt(0)
    s_sub_u32 s90, s90, s59
    s_cmp_lt_i32 s90, 0
    s_cbranch_scc1 L_pc14
L_pg14:
    s_add_u32 m0, s22, 12288
    s_xor_b32 s24, s20, 0xe1000
    buffer_load_dwordx4 v2, s[8:11], s24 offen offset:0 nt lds
    buffer_load_dwordx4 v3, s[8:11], s24 offen offset:1024 nt lds
    buffer_load_dwordx4 v4, s[8:11], s24 offen offset:2048 nt lds
    buffer_load_dwordx4 v5, s[8:11], s24 offen offset:3072 nt lds
    v_cvt_pk_bf16_f32 v40, v24, v25
    v_cvt_pk_bf16_f32 v41, v26, v27
    v_lshlrev_b32 v36, 16, v40
    v_and_b32 v37, 0xffff0000, v40
    v_lshlrev_b32 v38, 16, v41
    v_and_b32 v39, 0xffff0000, v41
    v_mul_f32 v36, s27, v36
    v_mul_f32 v37, s27, v37
    v_mul_f32 v38, s27, v38
    v_mul_f32 v39, s27, v39
    v_cvt_pk_bf16_f32 v40, v36, v37
    v_cvt_pk_bf16_f32 v41, v38, v39
    v_max3_f32 v21, v36, v37, v21
    ds_write_b64 v6, v[40:41] offset:1024
    v_max3_f32 v21, v38, v39, v21
    s_waitcnt vmcnt(16)
    ds_write_b128 v119, a[96:99] offset:28672
    ds_write_b128 v119, a[100:103] offset:29696
    ds_write_b128 v119, a[104:107] offset:30720
    ds_write_b128 v119, a[108:111] offset:31744
    ds_read_b128 v[48:51], v8 offset:28672
    ds_read_b128 v[52:55], v9 offset:28672
    ds_read_b128 v[56:59], v10 offset:28672
    ds_read_b128 v[60:63], v11 offset:28672
    ds_write_b128 v119, a[112:115] offset:28672
    ds_write_b128 v119, a[116:119] offset:29696
    ds_write_b128 v119, a[120:123] offset:30720
    ds_write_b128 v119, a[124:127] offset:31744
    ds_read_b128 v[64:67], v8 offset:28672
    ds_read_b128 v[68:71], v9 offset:28672
    ds_read_b128 v[72:75], v10 offset:28672
    ds_read_b128 v[76:79], v11 offset:28672
    s_waitcnt lgkmcnt(8)
    v_mfma_f32_16x16x32_bf16 v[24:27], v[48:51], a[0:3], 0
    v_mfma_f32_16x16x32_bf16 v[24:27], v[52:55], a[4:7], v[24:27]
    v_mfma_f32_16x16x32_bf16 v[24:27], v[56:59], a[8:11], v[24:27]
    v_mfma_f32_16x16x32_bf16 v[24:27], v[60:63], a[12:15], v[24:27]
    s_waitcnt lgkmcnt(0)
    v_mfma_f32_16x16x32_bf16 v[24:27], v[64:67], a[16:19], v[24:27]
    v_mfma_f32_16x16x32_bf16 v[24:27], v[68:71], a[20:23], v[24:27]
    v_mfma_f32_16x16x32_bf16 v[24:27], v[72:75], a[24:27], v[24:27]
    v_mfma_f32_16x16x32_bf16 v[24:27], v[76:79], a[28:31], v[24:27]
    s_nop 7
    s_nop 3
    v_cvt_pk_bf16_f32 v40, v24, v25
    v_cvt_pk_bf16_f32 v41, v26, v27
    v_lshlrev_b32 v36, 16, v40
    v_and_b32 v37, 0xffff0000, v40
    v_lshlrev_b32 v38, 16, v41
    v_and_b32 v39, 0xffff0000, v41
    v_mul_f32 v36, s27, v36
    v_mul_f32 v37, s27, v37
    v_mul_f32 v38, s27, v38
    v_mul_f32 v39, s27, v39
    v_cvt_pk_bf16_f32 v40, v36, v37
    v_cvt_pk_bf16_f32 v41, v38, v39
    v_max3_f32 v21, v36, v37, v21
    ds_write_b64 v6, v[40:41] offset:1280
    v_max3_f32 v21, v38, v39, v21
    v_add_u32 v6, 1536, v6
    s_mov_b32 s61, 0x100000
    s_add_u32 s23, s22, 16384
L_K:
    s_waitcnt vmcnt(12)
    ds_read_b128 v[48:51], v8 offset:0
    ds_read_b128 v[52:55], v9 offset:0
    ds_read_b128 v[56:59], v10 offset:0
    ds_read_b128 v[60:63], v11 offset:0
    ds_read_b32 v34, v32 offset:0
    s_memrealtime s[90:91]
    s_waitcnt lgkmcnt(0)
    v_mfma_f32_16x16x32_bf16 v[24:27], v[48:51], a[0:3], 0
    v_mfma_f32_16x16x32_bf16 v[24:27], v[52:55], a[4:7], v[24:27]
    v_mfma_f32_16x16x32_bf16 v[24:27], v[56:59], a[8:11], v[24:27]
    v_mfma_f32_16x16x32_bf16 v[24:27], v[60:63], a[12:15], v[24:27]
    s_add_u32 m0, s23, 0
    s_xor_b32 s21, s20, s61
    s_mov_b32 s24, s21
    s_add_u32 s58, s58, s42
    s_getreg_b32 s46, hwreg(HW_REG_IB_STS, 0, 4)
    v_readfirstlane_b32 s45, v34
    s_min_u32 s48, s46, 8
    s_max_i32 s45, s45, 0
    s_ashr_i32 s45, s45, 2
    s_add_u32 s59, s58, s45
    s_lshr_b32 s59, s59, 4
    s_add_u32 s59, s59, s60
    s_sub_u32 s90, s90, s59
    s_cmp_ge_i32 s90, 0
    s_cbranch_scc1 L_pg15
L_pc15:
    s_memrealtime s[90:91]
    s_waitcnt lgkmcnt(0)
    s_sub_u32 s90, s90, s59
    s_cmp_lt_i32 s90, 0
    s_cbranch_scc1 L_pc15
L_pg15:
    buffer_load_dwordx4 v2, s[8:11], s24 offen offset:0 nt lds
    buffer_load_dwordx4 v3, s[8:11], s24 offen offset:1024 nt lds
    buffer_load_dwordx4 v4, s[8:11], s24 offen offset:2048 nt lds
    buffer_load_dwordx4 v5, s[8:11], s24 offen offset:3072 nt lds
    s_waitcnt vmcnt(12)
    ds_read_b128 v[64:67], v8 offset:4096
    ds_read_b128 v[68:71], v9 offset:4096
    ds_read_b128 v[72:75], v10 offset:4096
    ds_read_b128 v[76:79], v11 offset:4096
    ds_read_b32 v34, v32 offset:0
    s_memrealtime s[90:91]
    s_waitcnt lgkmcnt(0)
    v_mfma_f32_16x16x32_bf16 v[24:27], v[64:67], a[16:19], v[24:27]
    v_mfma_f32_16x16x32_bf16 v[24:27], v[68:71], a[20:23], v[24:27]
    v_mfma_f32_16x16x32_bf16 v[24:27], v[72:75], a[24:27], v[24:27]
    v_mfma_f32_16x16x32_bf16 v[24:27], v[76:79], a[28:31], v[24:27]
    s_add_u32 m0, s23, 4096
    s_add_u32 s24, s21, 4096
    s_add_u32 s58, s58, s42
    s_getreg_b32 s46, hwreg(HW_REG_IB_STS, 0, 4)
    v_readfirstlane_b32 s45, v34
    s_min_u32 s49, s46, 8
    s_max_i32 s45, s45, 0
    s_ashr_i32 s45, s45, 2
    s_add_u32 s59, s58, s45
    s_lshr_b32 s59, s59, 4
    s_add_u32 s59, s59, s60
    s_sub_u32 s90, s90, s59
    s_cmp_ge_i32 s90, 0
    s_cbranch_scc1 L_pg16
L_pc16:
    s_memrealtime s[90:91]
    s_waitcnt lgkmcnt(0)
    s_sub_u32 s90, s90, s59
    s_cmp_lt_i32 s90, 0
    s_cbranch_scc1 L_pc16
L_pg16:
    buffer_load_dwordx4 v2, s[8:11], s24 offen offset:0 nt lds
    buffer_load_dwordx4 v3, s[8:11], s24 offen offset:1024 nt lds
    buffer_load_dwordx4 v4, s[8:11], s24 offen offset:2048 nt lds
    buffer_load_dwordx4 v5, s[8:11], s24 offen offset:3072 nt lds
    s_add_u32 s46, s48, s49
    s_mul_i32 s46, s46, 16
    s_sub_u32 s46, s46, 192
    s_mov_b64 exec, 1
    v_mov_b32 v33, s46
    ds_add_u32 v32, v33
    ds_max_i32 v32, v35
    s_mov_b64 exec, -1
    s_add_u32 s61, s61, 0x20000
    s_cmp_eq_u32 s23, s62
    s_cselect_b32 s28, 0xffffc000, s63
    s_add_u32 s23, s23, s28
    s_cmp_eq_u32 s23, s62
    s_cselect_b32 s28, 0xffffc000, s63
    v_add_u32 v8, s28, v8
    v_add_u32 v9, s28, v9
    v_add_u32 v10, s28, v10
    v_add_u32 v11, s28, v11
    v_cvt_pk_bf16_f32 v40, v24, v25
    v_cvt_pk_bf16_f32 v41, v26, v27
    v_lshlrev_b32 v36, 16, v40
    v_and_b32 v37, 0xffff0000, v40
    v_lshlrev_b32 v38, 16, v41
    v_and_b32 v39, 0xffff0000, v41
    v_mul_f32 v36, s27, v36
    v_mul_f32 v37, s27, v37
    v_mul_f32 v38, s27, v38
    v_mul_f32 v39, s27, v39
    v_cvt_pk_bf16_f32 v40, v36, v37
    v_cvt_pk_bf16_f32 v41, v38, v39
    v_max3_f32 v21, v36, v37, v21
    ds_write_b64 v6, v[40:41] offset:0
    v_max3_f32 v21, v38, v39, v21
    v_add_u32 v6, 256, v6
    s_cmp_eq_u32 s61, 0x40000
    s_cbranch_scc1 L_Kend
    s_cmp_lg_u32 s61, 0x200000
    s_cbranch_scc1 L_K
    s_mov_b32 s8, s36
    s_and_b32 s9, s37, 0xffff
    v_add_u32 v2, 0x0, v122
    v_add_u32 v3, 0x0, v123
    v_add_u32 v4, 0x0, v122
    v_add_u32 v5, 0x0, v123
    s_mov_b32 s61, 0
    s_branch L_K
L_Kend:
    v_cvt_pk_bf16_f32 v21, v21, v21
    v_and_b32 v21, 0xffff0000, v21
    v_mul_f32 v42, s26, v21
    s_nop 1
    v_max_f32_dpp v43, v42, v42 row_ror:4 row_mask:0xf bank_mask:0xf
    v_mov_b32 v42, v43
    s_nop 1
    v_permlane16_swap_b32 v42, v43
    v_max_f32 v42, v42, v43
    v_mov_b32 v43, v42
    s_nop 1
    v_permlane32_swap_b32 v42, v43
    v_max_f32 v20, v42, v43
    s_lshl2_add_u32 s24, s29, 133408
    v_mov_b32 v42, s24
    v_mov_b32 v43, 1
    s_mov_b64 exec, 15
    ds_write_b32 v118, v20
    ds_write_b32 v42, v43
    s_mov_b64 exec, -1
L_V:
    ds_read_b64 v[40:41], v7
    v_add_u32 v7, 256, v7
    s_waitcnt lgkmcnt(0)
    v_lshlrev_b32 v36, 16, v40
    v_and_b32 v37, 0xffff0000, v40
    v_lshlrev_b32 v38, 16, v41
    v_and_b32 v39, 0xffff0000, v41
    v_fma_f32 v36, v36, s26, -v20
    v_fma_f32 v37, v37, s26, -v20
    v_fma_f32 v38, v38, s26, -v20
    v_fma_f32 v39, v39, s26, -v20
    v_exp_f32 v36, v36
    v_exp_f32 v37, v37
    v_exp_f32 v38, v38
    v_exp_f32 v39, v39
    s_nop 0
    v_cvt_pk_bf16_f32 v28, v36, v37
    v_cvt_pk_bf16_f32 v29, v38, v39
    s_nop 1
    v_mov_b32_dpp v30, v28 row_ror:12 row_mask:0xf bank_mask:0xf
    v_mov_b32_dpp v31, v29 row_ror:12 row_mask:0xf bank_mask:0xf
    s_waitcnt vmcnt(12)
    ds_read_b64_tr_b16 v[48:49], v12 offset:0
    ds_read_b64_tr_b16 v[52:53], v13 offset:0
    ds_read_b64_tr_b16 v[56:57], v14 offset:0
    ds_read_b64_tr_b16 v[60:61], v15 offset:0
    ds_read_b64_tr_b16 v[64:65], v16 offset:0
    ds_read_b64_tr_b16 v[68:69], v17 offset:0
    ds_read_b64_tr_b16 v[72:73], v18 offset:0
    ds_read_b64_tr_b16 v[76:77], v19 offset:0
    ds_read_b32 v34, v32 offset:0
    s_memrealtime s[90:91]
    s_waitcnt lgkmcnt(0)
    s_add_u32 m0, s23, 0
    s_xor_b32 s21, s20, s61
    s_mov_b32 s24, s21
    s_add_u32 s58, s58, s43
    s_getreg_b32 s46, hwreg(HW_REG_IB_STS, 0, 4)
    v_readfirstlane_b32 s45, v34
    s_min_u32 s48, s46, 8
    s_max_i32 s45, s45, 0
    s_ashr_i32 s45, s45, 2
    s_sub_u32 s50, s50, 24
    s_min_i32 s45, s45, s50
    s_add_u32 s59, s58, s45
    s_lshr_b32 s59, s59, 4
    s_add_u32 s59, s59, s60
    s_sub_u32 s90, s90, s59
    s_cmp_ge_i32 s90, 0
    s_cbranch_scc1 L_pg17
L_pc17:
    s_memrealtime s[90:91]
    s_waitcnt lgkmcnt(0)
    s_sub_u32 s90, s90, s59
    s_cmp_lt_i32 s90, 0
    s_cbranch_scc1 L_pc17
L_pg17:
    buffer_load_dwordx4 v2, s[8:11], s24 offen offset:0 nt lds
    buffer_load_dwordx4 v3, s[8:11], s24 offen offset:1024 nt lds
    buffer_load_dwordx4 v4, s[8:11], s24 offen offset:2048 nt lds
    buffer_load_dwordx4 v5, s[8:11], s24 offen offset:3072 nt lds
    s_waitcnt vmcnt(12)
    ds_read_b64_tr_b16 v[50:51], v12 offset:4096
    ds_read_b64_tr_b16 v[54:55], v13 offset:4096
    ds_read_b64_tr_b16 v[58:59], v14 offset:4096
    ds_read_b64_tr_b16 v[62:63], v15 offset:4096
    ds_read_b64_tr_b16 v[66:67], v16 offset:4096
    ds_read_b64_tr_b16 v[70:71], v17 offset:4096
    ds_read_b64_tr_b16 v[74:75], v18 offset:4096
    ds_read_b64_tr_b16 v[78:79], v19 offset:4096
    ds_read_b32 v34, v32 offset:0
    s_memrealtime s[90:91]
    s_waitcnt lgkmcnt(0)
    v_mfma_f32_16x16x32_bf16 v[80:83], v[48:51], v[28:31], v[80:83]
    v_mfma_f32_16x16x32_bf16 v[84:87], v[52:55], v[28:31], v[84:87]
    v_mfma_f32_16x16x32_bf16 v[88:91], v[56:59], v[28:31], v[88:91]
    v_mfma_f32_16x16x32_bf16 v[92:95], v[60:63], v[28:31], v[92:95]
    v_mfma_f32_16x16x32_bf16 v[96:99], v[64:67], v[28:31], v[96:99]
    v_mfma_f32_16x16x32_bf16 v[100:103], v[68:71], v[28:31], v[100:103]
    v_mfma_f32_16x16x32_bf16 v[104:107], v[72:75], v[28:31], v[104:107]
    v_mfma_f32_16x16x32_bf16 v[108:111], v[76:79], v[28:31], v[108:111]
    s_add_u32 m0, s23, 4096
    s_add_u32 s24, s21, 4096
    s_add_u32 s58, s58, s43
    s_getreg_b32 s46, hwreg(HW_REG_IB_STS, 0, 4)
    v_readfirstlane_b32 s45, v34
    s_min_u32 s49, s46, 8
    s_max_i32 s45, s45, 0
    s_ashr_i32 s45, s45, 2
    s_sub_u32 s50, s50, 24
    s_min_i32 s45, s45, s50
    s_add_u32 s59, s58, s45
    s_lshr_b32 s59, s59, 4
    s_add_u32 s59, s59, s60
    s_sub_u32 s90, s90, s59
    s_cmp_ge_i32 s90, 0
    s_cbranch_scc1 L_pg18
L_pc18:
    s_memrealtime s[90:91]
    s_waitcnt lgkmcnt(0)
    s_sub_u32 s90, s90, s59
    s_cmp_lt_i32 s90, 0
    s_cbranch_scc1 L_pc18
L_pg18:
    buffer_load_dwordx4 v2, s[8:11], s24 offen offset:0 nt lds
    buffer_load_dwordx4 v3, s[8:11], s24 offen offset:1024 nt lds
    buffer_load_dwordx4 v4, s[8:11], s24 offen offset:2048 nt lds
    buffer_load_dwordx4 v5, s[8:11], s24 offen offset:3072 nt lds
    s_add_u32 s46, s48, s49
    s_mul_i32 s46, s46, 16
    s_sub_u32 s46, s46, 179
    s_mov_b64 exec, 1
    v_mov_b32 v33, s46
    ds_add_u32 v32, v33
    ds_max_i32 v32, v35
    s_mov_b64 exec, -1
    s_add_u32 s61, s61, 0x20000
    s_cmp_eq_u32 s23, s62
    s_cselect_b32 s28, 0xffffc000, s63
    s_add_u32 s23, s23, s28
    s_cmp_eq_u32 s23, s62
    s_cselect_b32 s28, 0xffffc000, s63
    v_add_u32 v12, s28, v12
    v_add_u32 v13, s28, v13
    v_add_u32 v14, s28, v14
    v_add_u32 v15, s28, v15
    v_add_u32 v16, s28, v16
    v_add_u32 v17, s28, v17
    v_add_u32 v18, s28, v18
    v_add_u32 v19, s28, v19
    s_cmp_lg_u32 s61, 0x200000
    s_cbranch_scc1 L_V
    v_mov_b32 v3, 133396
    v_lshrrev_b32 v2, 3, v0
    v_and_b32 v4, 7, v0
    v_lshlrev_b32 v4, 4, v4
    v_lshl_add_u32 v2, v2, 10, v4
    v_lshlrev_b32 v4, 2, v0
    v_and_b32 v4, 0x60, v4
    v_xor_b32 v2, v2, v4
    v_xor_b32 v5, 32, v2
    s_mov_b32 s8, s40
    s_and_b32 s9, s41, 0xffff
    s_mov_b32 s10, 0x400000
    s_mov_b32 s11, 0x20000
    s_lshl2_add_u32 s24, s4, s7
    s_lshl2_add_u32 s24, s24, s29
    s_lshl_b32 s24, s24, 15
    s_lshl_b32 s21, s6, 7
    s_add_u32 s24, s24, s21
    s_lshl_b32 s21, s29, 12
    s_add_u32 m0, s21, 135168
    s_mov_b32 s70, 0x40000
L_wf:
    ds_read_b32 v4, v3 offset:0
    s_sub_u32 s70, s70, 1
    s_waitcnt lgkmcnt(0)
    v_cmp_ne_u32 vcc, 1, v4
    s_cbranch_vccz L_wfok
    s_sleep 4
    s_cmp_lg_u32 s70, 0
    s_cbranch_scc1 L_wf
L_wfok:
    ds_read_b64 v[40:41], v7
    v_add_u32 v7, 256, v7
    s_waitcnt lgkmcnt(0)
    v_lshlrev_b32 v36, 16, v40
    v_and_b32 v37, 0xffff0000, v40
    v_lshlrev_b32 v38, 16, v41
    v_and_b32 v39, 0xffff0000, v41
    v_fma_f32 v36, v36, s26, -v20
    v_fma_f32 v37, v37, s26, -v20
    v_fma_f32 v38, v38, s26, -v20
    v_fma_f32 v39, v39, s26, -v20
    v_exp_f32 v36, v36
    v_exp_f32 v37, v37
    v_exp_f32 v38, v38
    v_exp_f32 v39, v39
    s_nop 0
    v_cvt_pk_bf16_f32 v28, v36, v37
    v_cvt_pk_bf16_f32 v29, v38, v39
    s_nop 1
    v_mov_b32_dpp v30, v28 row_ror:12 row_mask:0xf bank_mask:0xf
    v_mov_b32_dpp v31, v29 row_ror:12 row_mask:0xf bank_mask:0xf
    s_waitcnt vmcnt(12)
    ds_read_b64_tr_b16 v[48:49], v12 offset:0
    ds_read_b64_tr_b16 v[52:53], v13 offset:0
    ds_read_b64_tr_b16 v[56:57], v14 offset:0
    ds_read_b64_tr_b16 v[60:61], v15 offset:0
    ds_read_b64_tr_b16 v[64:65], v16 offset:0
    ds_read_b64_tr_b16 v[68:69], v17 offset:0
    ds_read_b64_tr_b16 v[72:73], v18 offset:0
    ds_read_b64_tr_b16 v[76:77], v19 offset:0
    s_waitcnt vmcnt(8)
    ds_read_b64_tr_b16 v[50:51], v12 offset:4096
    ds_read_b64_tr_b16 v[54:55], v13 offset:4096
    ds_read_b64_tr_b16 v[58:59], v14 offset:4096
    ds_read_b64_tr_b16 v[62:63], v15 offset:4096
    ds_read_b64_tr_b16 v[66:67], v16 offset:4096
    ds_read_b64_tr_b16 v[70:71], v17 offset:4096
    ds_read_b64_tr_b16 v[74:75], v18 offset:4096
    ds_read_b64_tr_b16 v[78:79], v19 offset:4096
    s_add_u32 s61, s61, 0x20000
    s_cmp_eq_u32 s23, s62
    s_cselect_b32 s28, 0xffffc000, s63
    s_add_u32 s23, s23, s28
    s_cmp_eq_u32 s23, s62
    s_cselect_b32 s28, 0xffffc000, s63
    v_add_u32 v12, s28, v12
    v_add_u32 v13, s28, v13
    v_add_u32 v14, s28, v14
    v_add_u32 v15, s28, v15
    v_add_u32 v16, s28, v16
    v_add_u32 v17, s28, v17
    v_add_u32 v18, s28, v18
    v_add_u32 v19, s28, v19
    s_waitcnt lgkmcnt(4)
    v_mfma_f32_16x16x32_bf16 v[80:83], v[48:51], v[28:31], v[80:83]
    v_mfma_f32_16x16x32_bf16 v[84:87], v[52:55], v[28:31], v[84:87]
    v_mfma_f32_16x16x32_bf16 v[88:91], v[56:59], v[28:31], v[88:91]
    v_mfma_f32_16x16x32_bf16 v[92:95], v[60:63], v[28:31], v[92:95]
    s_waitcnt lgkmcnt(0)
    v_mfma_f32_16x16x32_bf16 v[96:99], v[64:67], v[28:31], v[96:99]
    v_mfma_f32_16x16x32_bf16 v[100:103], v[68:71], v[28:31], v[100:103]
    v_mfma_f32_16x16x32_bf16 v[104:107], v[72:75], v[28:31], v[104:107]
    v_mfma_f32_16x16x32_bf16 v[108:111], v[76:79], v[28:31], v[108:111]
    ds_read_b64 v[40:41], v7
    v_add_u32 v7, 256, v7
    s_waitcnt lgkmcnt(0)
    v_lshlrev_b32 v36, 16, v40
    v_and_b32 v37, 0xffff0000, v40
    v_lshlrev_b32 v38, 16, v41
    v_and_b32 v39, 0xffff0000, v41
    v_fma_f32 v36, v36, s26, -v20
    v_fma_f32 v37, v37, s26, -v20
    v_fma_f32 v38, v38, s26, -v20
    v_fma_f32 v39, v39, s26, -v20
    v_exp_f32 v36, v36
    v_exp_f32 v37, v37
    v_exp_f32 v38, v38
    v_exp_f32 v39, v39
    s_nop 0
    v_cvt_pk_bf16_f32 v28, v36, v37
    v_cvt_pk_bf16_f32 v29, v38, v39
    s_nop 1
    v_mov_b32_dpp v30, v28 row_ror:12 row_mask:0xf bank_mask:0xf
    v_mov_b32_dpp v31, v29 row_ror:12 row_mask:0xf bank_mask:0xf
    s_waitcnt vmcnt(4)
    ds_read_b64_tr_b16 v[48:49], v12 offset:0
    ds_read_b64_tr_b16 v[52:53], v13 offset:0
    ds_read_b64_tr_b16 v[56:57], v14 offset:0
    ds_read_b64_tr_b16 v[60:61], v15 offset:0
    ds_read_b64_tr_b16 v[64:65], v16 offset:0
    ds_read_b64_tr_b16 v[68:69], v17 offset:0
    ds_read_b64_tr_b16 v[72:73], v18 offset:0
    ds_read_b64_tr_b16 v[76:77], v19 offset:0
    s_add_u32 s58, s58, 1000
    s_add_u32 s59, s58, s45
    s_lshr_b32 s59, s59, 4
    s_add_u32 s59, s59, s60
L_pc19:
    s_memrealtime s[90:91]
    s_waitcnt lgkmcnt(0)
    s_sub_u32 s90, s90, s59
    s_cmp_lt_i32 s90, 0
    s_cbranch_scc1 L_pc19
L_pg19:
    buffer_load_dwordx4 v2, s[8:11], s24 offen nt lds
    s_add_u32 m0, m0, 1024
    s_add_u32 s24, s24, 8192
    buffer_load_dwordx4 v5, s[8:11], s24 offen nt lds
    s_add_u32 m0, m0, 1024
    s_add_u32 s24, s24, 8192
    buffer_load_dwordx4 v2, s[8:11], s24 offen nt lds
    s_add_u32 m0, m0, 1024
    s_add_u32 s24, s24, 8192
    buffer_load_dwordx4 v5, s[8:11], s24 offen nt lds
    s_waitcnt vmcnt(4)
    ds_read_b64_tr_b16 v[50:51], v12 offset:4096
    ds_read_b64_tr_b16 v[54:55], v13 offset:4096
    ds_read_b64_tr_b16 v[58:59], v14 offset:4096
    ds_read_b64_tr_b16 v[62:63], v15 offset:4096
    ds_read_b64_tr_b16 v[66:67], v16 offset:4096
    ds_read_b64_tr_b16 v[70:71], v17 offset:4096
    ds_read_b64_tr_b16 v[74:75], v18 offset:4096
    ds_read_b64_tr_b16 v[78:79], v19 offset:4096
    s_waitcnt lgkmcnt(4)
    v_mfma_f32_16x16x32_bf16 v[80:83], v[48:51], v[28:31], v[80:83]
    v_mfma_f32_16x16x32_bf16 v[84:87], v[52:55], v[28:31], v[84:87]
    v_mfma_f32_16x16x32_bf16 v[88:91], v[56:59], v[28:31], v[88:91]
    v_mfma_f32_16x16x32_bf16 v[92:95], v[60:63], v[28:31], v[92:95]
    s_waitcnt lgkmcnt(0)
    v_mfma_f32_16x16x32_bf16 v[96:99], v[64:67], v[28:31], v[96:99]
    v_mfma_f32_16x16x32_bf16 v[100:103], v[68:71], v[28:31], v[100:103]
    v_mfma_f32_16x16x32_bf16 v[104:107], v[72:75], v[28:31], v[104:107]
    v_mfma_f32_16x16x32_bf16 v[108:111], v[76:79], v[28:31], v[108:111]
    s_mov_b64 exec, s[38:39]
    s_nop 2
    ds_write_b128 v116, v[80:83] offset:0
    ds_write_b128 v116, v[84:87] offset:64
    ds_write_b128 v116, v[88:91] offset:128
    ds_write_b128 v116, v[92:95] offset:192
    s_nop 2
    ds_write_b128 v116, v[96:99] offset:256
    ds_write_b128 v116, v[100:103] offset:320
    ds_write_b128 v116, v[104:107] offset:384
    ds_write_b128 v116, v[108:111] offset:448
    s_mov_b64 exec, -1
    s_waitcnt lgkmcnt(0)
    s_barrier
    s_branch L_gather
L_Hx:
    v_and_b32 v2, 15, v0
    v_lshrrev_b32 v6, 2, v2
    v_lshl_add_u32 v6, v3, 3, v6
    v_lshlrev_b32 v6, 7, v6
    v_and_b32 v7, 3, v0
    v_lshl_add_u32 v6, v7, 3, v6
    s_mov_b32 s92, 0x7060500
    s_mov_b32 s93, 0x7060501
    s_mov_b32 s94, 0x7060502
    s_mov_b32 s95, 0x7060503
    s_mov_b32 s64, 0x0c0c0400
    s_mov_b32 s65, 0x04000c0c
    s_load_dword s88, s[56:57], 0
    s_mov_b32 s16, s56
    s_and_b32 s17, s57, 0xffff
    s_mov_b32 s18, 0x1000000
    s_mov_b32 s19, 0x20000
    s_waitcnt lgkmcnt(0)
    s_add_u32 s88, s88, 0x1010101
    v_mov_b32 v126, s88
    s_cmp_eq_u32 s3, 2
    s_cbranch_scc1 L_H2
    s_cmp_eq_u32 s3, 3
    s_cbranch_scc1 L_H3
    s_cmp_ge_u32 s4, 4
    s_cselect_b32 s71, 24, 0
    s_sub_u32 s71, s96, s71
    s_lshl_b32 s66, s71, 8
    v_mov_b32 v12, s66
    v_perm_b32 v16, v12, v126, s92
    v_perm_b32 v17, v12, v126, s93
    v_perm_b32 v18, v12, v126, s94
    v_perm_b32 v19, v12, v126, s95
    s_lshr_b32 s67, s2, 3
    s_lshl_b32 s67, s67, 7
    s_add_u32 s67, s67, 327680
    s_lshl_b32 s20, s4, 4
    v_mov_b32 v12, s20
    s_cmp_eq_u32 s67, 329728
    s_cselect_b64 exec, 1, 0
    s_mov_b32 s67, 329728
    buffer_store_dwordx4 v[16:19], v12, s[16:19], s67 offen sc1
    s_mov_b64 exec, -1
    s_mov_b32 s24, s32
    s_and_b32 s25, s33, 0xffff
    s_mov_b32 s26, 0x2000
    s_mov_b32 s27, 0x20000
    s_mov_b32 s28, s50
    s_and_b32 s29, s51, 0xffff
    s_mov_b32 s30, 0x400
    s_mov_b32 s31, 0x20000
    v_lshlrev_b32 v8, 4, v0
    s_lshl_b32 s59, s6, 10
    buffer_load_dwordx4 v[16:19], v8, s[24:27], s59 offen
    buffer_load_dwordx4 v[20:23], v8, s[28:31], 0 offen
    s_waitcnt vmcnt(0)
    v_lshlrev_b32 v24, 16, v16
    v_and_b32 v25, 0xffff0000, v16
    v_lshlrev_b32 v32, 16, v20
    v_and_b32 v33, 0xffff0000, v20
    v_lshlrev_b32 v26, 16, v17
    v_and_b32 v27, 0xffff0000, v17
    v_lshlrev_b32 v34, 16, v21
    v_and_b32 v35, 0xffff0000, v21
    v_lshlrev_b32 v28, 16, v18
    v_and_b32 v29, 0xffff0000, v18
    v_lshlrev_b32 v36, 16, v22
    v_and_b32 v37, 0xffff0000, v22
    v_lshlrev_b32 v30, 16, v19
    v_and_b32 v31, 0xffff0000, v19
    v_lshlrev_b32 v38, 16, v23
    v_and_b32 v39, 0xffff0000, v23
    v_mul_f32 v24, v24, v32
    v_mul_f32 v25, v25, v33
    v_mul_f32 v26, v26, v34
    v_mul_f32 v27, v27, v35
    v_mul_f32 v28, v28, v36
    v_mul_f32 v29, v29, v37
    v_mul_f32 v30, v30, v38
    v_mul_f32 v31, v31, v39
    v_cvt_pk_bf16_f32 v32, v24, v25
    v_cvt_pk_bf16_f32 v33, v26, v27
    v_cvt_pk_bf16_f32 v34, v28, v29
    v_cvt_pk_bf16_f32 v35, v30, v31
    v_lshlrev_b32 v24, 16, v32
    v_and_b32 v25, 0xffff0000, v32
    v_lshlrev_b32 v26, 16, v33
    v_and_b32 v27, 0xffff0000, v33
    v_lshlrev_b32 v28, 16, v34
    v_and_b32 v29, 0xffff0000, v34
    v_lshlrev_b32 v30, 16, v35
    v_and_b32 v31, 0xffff0000, v35
    v_add_f32 v24, v24, v25
    v_add_f32 v26, v26, v27
    v_add_f32 v28, v28, v29
    v_add_f32 v30, v30, v31
    v_add_f32 v24, v24, v26
    v_add_f32 v28, v28, v30
    v_add_f32 v24, v24, v28
    s_nop 1
    v_add_f32_dpp v25, v24, v24 row_ror:1 row_mask:0xf bank_mask:0xf
    v_mov_b32 v24, v25
    s_nop 1
    v_add_f32_dpp v25, v24, v24 row_ror:2 row_mask:0xf bank_mask:0xf
    v_mov_b32 v24, v25
    s_nop 1
    v_add_f32_dpp v25, v24, v24 row_ror:4 row_mask:0xf bank_mask:0xf
    v_mov_b32 v24, v25
    s_nop 1
    v_add_f32_dpp v25, v24, v24 row_ror:8 row_mask:0xf bank_mask:0xf
    v_mov_b32 v24, v25
    s_nop 1
    v_permlane16_swap_b32 v24, v25
    v_add_f32 v24, v24, v25
    v_mov_b32 v25, v24
    s_nop 1
    v_permlane32_swap_b32 v24, v25
    v_add_f32 v24, v24, v25
    v_cvt_pk_bf16_f32 v24, v24, v24
    v_and_b32 v24, 0xffff0000, v24
    v_mul_f32 v24, 0xbfb8aa3b, v24
    v_exp_f32 v24, v24
    s_nop 0
    v_add_f32 v24, 1.0, v24
    v_rcp_f32 v24, v24
    s_nop 0
    v_cvt_pk_bf16_f32 v24, v24, v24
    v_and_b32 v117, 0xffff0000, v24
    v_sub_f32 v118, 1.0, v117
    v_cvt_pk_bf16_f32 v118, v118, v118
    v_and_b32 v118, 0xffff0000, v118
    s_lshl_b32 s58, s89, 13
    s_add_u32 s58, s58, 1048576
    s_add_u32 s59, s58, 4096
    v_lshlrev_b32 v26, 4, v0
    v_lshlrev_b32 v25, 3, v0
    v_add_u32 v25, 131072, v25
    s_mov_b32 s70, 0x40000
    s_mov_b64 s[40:41], -1
    s_mov_b64 s[42:43], -1
    s_mov_b64 s[44:45], -1
    s_mov_b64 s[46:47], -1
    v_mov_b32 v12, 1
    v_mov_b32 v14, 133400
L_wt0:
    s_sleep 2
    s_memrealtime s[90:91]
    s_waitcnt lgkmcnt(0)
    s_sub_u32 s90, s90, s96
    s_cmp_lt_u32 s90, 380
    s_cbranch_scc1 L_wt0
    s_mov_b64 exec, 0xff
    buffer_load_dwordx4 v[80:83], v26, s[16:19], s67 offen sc1
    s_mov_b64 exec, -1
    v_xor_b32 v126, 0x80808080, v126
L_pollqn:
    s_mov_b64 exec, s[40:41]
    buffer_load_dwordx4 v[32:35], v26, s[16:19], s58 offen offset:0 nt
    buffer_load_dwordx4 v[36:39], v26, s[16:19], s58 offen offset:1024 nt
    s_mov_b64 exec, s[42:43]
    buffer_load_dwordx4 v[40:43], v26, s[16:19], s58 offen offset:2048 nt
    buffer_load_dwordx4 v[44:47], v26, s[16:19], s58 offen offset:3072 nt
    s_mov_b64 exec, s[44:45]
    buffer_load_dwordx4 v[48:51], v26, s[16:19], s59 offen offset:0 nt
    buffer_load_dwordx4 v[52:55], v26, s[16:19], s59 offen offset:1024 nt
    s_mov_b64 exec, s[46:47]
    buffer_load_dwordx4 v[56:59], v26, s[16:19], s59 offen offset:2048 nt
    buffer_load_dwordx4 v[60:63], v26, s[16:19], s59 offen offset:3072 nt
    s_mov_b64 exec, -1
    s_branch L_pollqc
L_pollq:
    s_mov_b64 exec, s[40:41]
    buffer_load_dwordx4 v[32:35], v26, s[16:19], s58 offen offset:0 sc1
    buffer_load_dwordx4 v[36:39], v26, s[16:19], s58 offen offset:1024 sc1
    s_mov_b64 exec, s[42:43]
    buffer_load_dwordx4 v[40:43], v26, s[16:19], s58 offen offset:2048 sc1
    buffer_load_dwordx4 v[44:47], v26, s[16:19], s58 offen offset:3072 sc1
    s_mov_b64 exec, s[44:45]
    buffer_load_dwordx4 v[48:51], v26, s[16:19], s59 offen offset:0 sc1
    buffer_load_dwordx4 v[52:55], v26, s[16:19], s59 offen offset:1024 sc1
    s_mov_b64 exec, s[46:47]
    buffer_load_dwordx4 v[56:59], v26, s[16:19], s59 offen offset:2048 sc1
    buffer_load_dwordx4 v[60:63], v26, s[16:19], s59 offen offset:3072 sc1
    s_mov_b64 exec, -1
L_pollqc:
    s_waitcnt vmcnt(0)
    v_perm_b32 v28, v33, v32, s64
    v_perm_b32 v29, v35, v34, s65
    v_or_b32 v27, v28, v29
    v_xor_b32 v27, v126, v27
    v_perm_b32 v28, v37, v36, s64
    v_perm_b32 v29, v39, v38, s65
    v_or_b32 v28, v28, v29
    v_xor_b32 v28, v126, v28
    v_or_b32 v27, v27, v28
    v_cmp_ne_u32 s[40:41], 0, v27
    v_perm_b32 v28, v41, v40, s64
    v_perm_b32 v29, v43, v42, s65
    v_or_b32 v27, v28, v29
    v_xor_b32 v27, v126, v27
    v_perm_b32 v28, v45, v44, s64
    v_perm_b32 v29, v47, v46, s65
    v_or_b32 v28, v28, v29
    v_xor_b32 v28, v126, v28
    v_or_b32 v27, v27, v28
    v_cmp_ne_u32 s[42:43], 0, v27
    v_perm_b32 v28, v49, v48, s64
    v_perm_b32 v29, v51, v50, s65
    v_or_b32 v27, v28, v29
    v_xor_b32 v27, v126, v27
    v_perm_b32 v28, v53, v52, s64
    v_perm_b32 v29, v55, v54, s65
    v_or_b32 v28, v28, v29
    v_xor_b32 v28, v126, v28
    v_or_b32 v27, v27, v28
    v_cmp_ne_u32 s[44:45], 0, v27
    v_perm_b32 v28, v57, v56, s64
    v_perm_b32 v29, v59, v58, s65
    v_or_b32 v27, v28, v29
    v_xor_b32 v27, v126, v27
    v_perm_b32 v28, v61, v60, s64
    v_perm_b32 v29, v63, v62, s65
    v_or_b32 v28, v28, v29
    v_xor_b32 v28, v126, v28
    v_or_b32 v27, v27, v28
    v_cmp_ne_u32 s[46:47], 0, v27
    v_add_f32 v64, v32, v40
    v_add_f32 v72, v48, v56
    v_add_f32 v65, v33, v41
    v_add_f32 v73, v49, v57
    v_add_f32 v66, v34, v42
    v_add_f32 v74, v50, v58
    v_add_f32 v67, v35, v43
    v_add_f32 v75, v51, v59
    v_add_f32 v68, v36, v44
    v_add_f32 v76, v52, v60
    v_add_f32 v69, v37, v45
    v_add_f32 v77, v53, v61
    v_add_f32 v70, v38, v46
    v_add_f32 v78, v54, v62
    v_add_f32 v71, v39, v47
    v_add_f32 v79, v55, v63
    s_or_b64 s[60:61], s[40:41], s[42:43]
    s_or_b64 s[62:63], s[44:45], s[46:47]
    s_or_b64 vcc, s[60:61], s[62:63]
    s_cbranch_scc0 L_qok
    s_sleep 8
    s_sub_u32 s70, s70, 1
    s_bitcmp0_b32 s70, 0
    s_cbranch_scc1 L_pollqn
    s_cmp_gt_u32 s70, 1
    s_cbranch_scc1 L_pollq
L_qok:
    v_xor_b32 v126, 0x80808080, v126
    v_add_f32 v64, v64, v72
    v_add_f32 v65, v65, v73
    v_add_f32 v66, v66, v74
    v_add_f32 v67, v67, v75
    v_add_f32 v68, v68, v76
    v_add_f32 v69, v69, v77
    v_add_f32 v70, v70, v78
    v_add_f32 v71, v71, v79
    v_cvt_pk_bf16_f32 v72, v64, v65
    v_cvt_pk_bf16_f32 v73, v66, v67
    v_cvt_pk_bf16_f32 v74, v68, v69
    v_cvt_pk_bf16_f32 v75, v70, v71
    ds_write_b64 v25, v[72:73] offset:0
    ds_write_b64 v25, v[74:75] offset:512
    s_mov_b64 exec, 0xff
    v_perm_b32 v28, v81, v80, s64
    v_perm_b32 v29, v83, v82, s65
    v_or_b32 v27, v28, v29
    v_xor_b32 v27, v126, v27
    v_subrev_u32 v13, s66, v80
    v_ashrrev_i32 v13, 8, v13
    v_cmp_eq_u32 vcc, 0, v27
    v_min_i32 v13, 0xc8, v13
    v_max_i32 v13, 0xffffff38, v13
    v_cndmask_b32 v13, 0, v13, vcc
    s_nop 1
    v_add_u32_dpp v27, v13, v13 quad_perm:[1,0,3,2] row_mask:0xf bank_mask:0xf
    s_nop 1
    v_add_u32_dpp v13, v27, v27 quad_perm:[2,3,0,1] row_mask:0xf bank_mask:0xf
    s_nop 1
    v_max_i32_dpp v27, v13, v13 row_half_mirror row_mask:0xf bank_mask:0xf
    v_ashrrev_i32 v13, 2, v27
    v_add_u32 v13, s71, v13
    s_nop 0
    v_readfirstlane_b32 s71, v13
    s_mov_b64 exec, 1
    ds_write_b64 v14, v[12:13]
    s_mov_b64 exec, -1
    s_branch L_Hbar2
L_H3:
    s_lshr_b32 s20, s6, 2
    s_lshl3_add_u32 s20, s20, s4
    s_bfe_u32 s21, s6, 0x10001
    s_lshl1_add_u32 s68, s20, s21
    s_and_b32 s20, s2, 0x38
    s_cmp_eq_u32 s20, 0x18
    s_cselect_b32 s68, s68, 99
    s_cmp_ge_u32 s68, 28
    s_cbranch_scc1 L_Hbar2
    v_lshlrev_b32 v9, 4, v5
    v_lshl_add_u32 v9, v3, 5, v9
    v_bfe_u32 v10, v0, 3, 1
    v_lshl_add_u32 v9, v10, 4, v9
    v_lshlrev_b32 v26, 4, v0
    s_lshl_b32 s40, s68, 14
    s_add_u32 s40, s40, 3670016
    s_add_u32 s41, s40, 4096
    s_add_u32 s42, s40, 8192
    s_add_u32 s43, s40, 12288
    s_lshl_b32 s58, s68, 11
    s_add_u32 s58, s58, 458752
    s_mov_b32 s20, 0x05040c00
    s_mov_b32 s21, 0x07060c01
    s_mov_b32 s22, 0x05040c02
    s_mov_b32 s23, 0x07060c03
    s_mov_b32 s61, 0x3d372713
    s_mov_b32 s63, 0x40135761
    s_mov_b32 s70, 0x8000
    v_add_u32 v27, 0x400000, v26
L_wt1:
    s_sleep 16
    s_memrealtime s[90:91]
    s_waitcnt lgkmcnt(0)
    s_sub_u32 s90, s90, s96
    s_cmp_lt_u32 s90, 900
    s_cbranch_scc1 L_wt1
L_rpn:
    buffer_load_dwordx4 v[32:35], v9, s[16:19], s40 offen offset:0 nt
    buffer_load_dwordx4 v[36:39], v9, s[16:19], s40 offen offset:128 nt
    buffer_load_dwordx4 v[40:43], v9, s[16:19], s40 offen offset:2048 nt
    buffer_load_dwordx4 v[44:47], v9, s[16:19], s40 offen offset:2176 nt
    buffer_load_dwordx4 v[48:51], v9, s[16:19], s41 offen offset:0 nt
    buffer_load_dwordx4 v[52:55], v9, s[16:19], s41 offen offset:128 nt
    buffer_load_dwordx4 v[56:59], v9, s[16:19], s41 offen offset:2048 nt
    buffer_load_dwordx4 v[60:63], v9, s[16:19], s41 offen offset:2176 nt
    buffer_load_dwordx4 v[64:67], v9, s[16:19], s42 offen offset:0 nt
    buffer_load_dwordx4 v[68:71], v9, s[16:19], s42 offen offset:128 nt
    buffer_load_dwordx4 v[72:75], v9, s[16:19], s42 offen offset:2048 nt
    buffer_load_dwordx4 v[76:79], v9, s[16:19], s42 offen offset:2176 nt
    buffer_load_dwordx4 v[80:83], v9, s[16:19], s43 offen offset:0 nt
    buffer_load_dwordx4 v[84:87], v9, s[16:19], s43 offen offset:128 nt
    buffer_load_dwordx4 v[88:91], v9, s[16:19], s43 offen offset:2048 nt
    buffer_load_dwordx4 v[92:95], v9, s[16:19], s43 offen offset:2176 nt
    s_branch L_rpc
L_rp:
    buffer_load_dwordx4 v[32:35], v9, s[16:19], s40 offen offset:0 sc1
    buffer_load_dwordx4 v[36:39], v9, s[16:19], s40 offen offset:128 sc1
    buffer_load_dwordx4 v[40:43], v9, s[16:19], s40 offen offset:2048 sc1
    buffer_load_dwordx4 v[44:47], v9, s[16:19], s40 offen offset:2176 sc1
    buffer_load_dwordx4 v[48:51], v9, s[16:19], s41 offen offset:0 sc1
    buffer_load_dwordx4 v[52:55], v9, s[16:19], s41 offen offset:128 sc1
    buffer_load_dwordx4 v[56:59], v9, s[16:19], s41 offen offset:2048 sc1
    buffer_load_dwordx4 v[60:63], v9, s[16:19], s41 offen offset:2176 sc1
    buffer_load_dwordx4 v[64:67], v9, s[16:19], s42 offen offset:0 sc1
    buffer_load_dwordx4 v[68:71], v9, s[16:19], s42 offen offset:128 sc1
    buffer_load_dwordx4 v[72:75], v9, s[16:19], s42 offen offset:2048 sc1
    buffer_load_dwordx4 v[76:79], v9, s[16:19], s42 offen offset:2176 sc1
    buffer_load_dwordx4 v[80:83], v9, s[16:19], s43 offen offset:0 sc1
    buffer_load_dwordx4 v[84:87], v9, s[16:19], s43 offen offset:128 sc1
    buffer_load_dwordx4 v[88:91], v9, s[16:19], s43 offen offset:2048 sc1
    buffer_load_dwordx4 v[92:95], v9, s[16:19], s43 offen offset:2176 sc1
L_rpc:
    s_sub_u32 s70, s70, 1
    s_waitcnt vmcnt(0)
    v_perm_b32 v11, v33, v32, s64
    v_perm_b32 v12, v35, v34, s65
    v_or_b32 v10, v11, v12
    v_xor_b32 v10, v126, v10
    v_perm_b32 v11, v37, v36, s64
    v_perm_b32 v12, v39, v38, s65
    v_or_b32 v11, v11, v12
    v_xor_b32 v11, v126, v11
    v_or_b32 v10, v10, v11
    v_perm_b32 v11, v41, v40, s64
    v_perm_b32 v12, v43, v42, s65
    v_or_b32 v11, v11, v12
    v_xor_b32 v11, v126, v11
    v_or_b32 v10, v10, v11
    v_perm_b32 v11, v45, v44, s64
    v_perm_b32 v12, v47, v46, s65
    v_or_b32 v11, v11, v12
    v_xor_b32 v11, v126, v11
    v_or_b32 v10, v10, v11
    v_perm_b32 v11, v49, v48, s64
    v_perm_b32 v12, v51, v50, s65
    v_or_b32 v11, v11, v12
    v_xor_b32 v11, v126, v11
    v_or_b32 v10, v10, v11
    v_perm_b32 v11, v53, v52, s64
    v_perm_b32 v12, v55, v54, s65
    v_or_b32 v11, v11, v12
    v_xor_b32 v11, v126, v11
    v_or_b32 v10, v10, v11
    v_perm_b32 v11, v57, v56, s64
    v_perm_b32 v12, v59, v58, s65
    v_or_b32 v11, v11, v12
    v_xor_b32 v11, v126, v11
    v_or_b32 v10, v10, v11
    v_perm_b32 v11, v61, v60, s64
    v_perm_b32 v12, v63, v62, s65
    v_or_b32 v11, v11, v12
    v_xor_b32 v11, v126, v11
    v_or_b32 v10, v10, v11
    v_perm_b32 v11, v65, v64, s64
    v_perm_b32 v12, v67, v66, s65
    v_or_b32 v11, v11, v12
    v_xor_b32 v11, v126, v11
    v_or_b32 v10, v10, v11
    v_perm_b32 v11, v69, v68, s64
    v_perm_b32 v12, v71, v70, s65
    v_or_b32 v11, v11, v12
    v_xor_b32 v11, v126, v11
    v_or_b32 v10, v10, v11
    v_perm_b32 v11, v73, v72, s64
    v_perm_b32 v12, v75, v74, s65
    v_or_b32 v11, v11, v12
    v_xor_b32 v11, v126, v11
    v_or_b32 v10, v10, v11
    v_perm_b32 v11, v77, v76, s64
    v_perm_b32 v12, v79, v78, s65
    v_or_b32 v11, v11, v12
    v_xor_b32 v11, v126, v11
    v_or_b32 v10, v10, v11
    v_perm_b32 v11, v81, v80, s64
    v_perm_b32 v12, v83, v82, s65
    v_or_b32 v11, v11, v12
    v_xor_b32 v11, v126, v11
    v_or_b32 v10, v10, v11
    v_perm_b32 v11, v85, v84, s64
    v_perm_b32 v12, v87, v86, s65
    v_or_b32 v11, v11, v12
    v_xor_b32 v11, v126, v11
    v_or_b32 v10, v10, v11
    v_perm_b32 v11, v89, v88, s64
    v_perm_b32 v12, v91, v90, s65
    v_or_b32 v11, v11, v12
    v_xor_b32 v11, v126, v11
    v_or_b32 v10, v10, v11
    v_perm_b32 v11, v93, v92, s64
    v_perm_b32 v12, v95, v94, s65
    v_or_b32 v11, v11, v12
    v_xor_b32 v11, v126, v11
    v_or_b32 v10, v10, v11
    v_cmp_ne_u32 vcc, 0, v10
    s_cbranch_vccz L_rpok
    s_sleep 64
    s_and_b32 s31, s70, 1
    s_cmp_lg_u32 s31, 1
    s_cbranch_scc1 L_rpn
    s_cmp_gt_u32 s70, 1
    s_cbranch_scc1 L_rp
L_rpok:
    v_add_f32 v32, v32, v40
    v_add_f32 v48, v48, v56
    v_add_f32 v33, v33, v41
    v_add_f32 v49, v49, v57
    v_add_f32 v34, v34, v42
    v_add_f32 v50, v50, v58
    v_add_f32 v35, v35, v43
    v_add_f32 v51, v51, v59
    v_add_f32 v36, v36, v44
    v_add_f32 v52, v52, v60
    v_add_f32 v37, v37, v45
    v_add_f32 v53, v53, v61
    v_add_f32 v38, v38, v46
    v_add_f32 v54, v54, v62
    v_add_f32 v39, v39, v47
    v_add_f32 v55, v55, v63
    v_add_f32 v32, v32, v48
    v_add_f32 v33, v33, v49
    v_add_f32 v34, v34, v50
    v_add_f32 v35, v35, v51
    v_add_f32 v36, v36, v52
    v_add_f32 v37, v37, v53
    v_add_f32 v38, v38, v54
    v_add_f32 v39, v39, v55
    v_add_f32 v64, v64, v72
    v_add_f32 v80, v80, v88
    v_add_f32 v65, v65, v73
    v_add_f32 v81, v81, v89
    v_add_f32 v66, v66, v74
    v_add_f32 v82, v82, v90
    v_add_f32 v67, v67, v75
    v_add_f32 v83, v83, v91
    v_add_f32 v68, v68, v76
    v_add_f32 v84, v84, v92
    v_add_f32 v69, v69, v77
    v_add_f32 v85, v85, v93
    v_add_f32 v70, v70, v78
    v_add_f32 v86, v86, v94
    v_add_f32 v71, v71, v79
    v_add_f32 v87, v87, v95
    v_add_f32 v64, v64, v80
    v_add_f32 v65, v65, v81
    v_add_f32 v66, v66, v82
    v_add_f32 v67, v67, v83
    v_add_f32 v68, v68, v84
    v_add_f32 v69, v69, v85
    v_add_f32 v70, v70, v86
    v_add_f32 v71, v71, v87
    v_cvt_pk_bf16_f32 v104, v32, v33
    v_cvt_pk_bf16_f32 v108, v64, v65
    v_cvt_pk_bf16_f32 v105, v34, v35
    v_cvt_pk_bf16_f32 v109, v66, v67
    v_cvt_pk_bf16_f32 v106, v36, v37
    v_cvt_pk_bf16_f32 v110, v68, v69
    v_cvt_pk_bf16_f32 v107, v38, v39
    v_cvt_pk_bf16_f32 v111, v70, v71
    v_lshlrev_b32 v32, 16, v104
    v_and_b32 v33, 0xffff0000, v104
    v_lshlrev_b32 v64, 16, v108
    v_and_b32 v65, 0xffff0000, v108
    v_lshlrev_b32 v34, 16, v105
    v_and_b32 v35, 0xffff0000, v105
    v_lshlrev_b32 v66, 16, v109
    v_and_b32 v67, 0xffff0000, v109
    v_lshlrev_b32 v36, 16, v106
    v_and_b32 v37, 0xffff0000, v106
    v_lshlrev_b32 v68, 16, v110
    v_and_b32 v69, 0xffff0000, v110
    v_lshlrev_b32 v38, 16, v107
    v_and_b32 v39, 0xffff0000, v107
    v_lshlrev_b32 v70, 16, v111
    v_and_b32 v71, 0xffff0000, v111
    v_mul_f32 v96, v32, v32
    v_mul_f32 v96, v96, v32
    v_fma_f32 v96, v96, s61, v32
    v_mul_f32 v96, s63, v96
    v_mul_f32 v97, v33, v33
    v_mul_f32 v97, v97, v33
    v_fma_f32 v97, v97, s61, v33
    v_mul_f32 v97, s63, v97
    v_mul_f32 v98, v34, v34
    v_mul_f32 v98, v98, v34
    v_fma_f32 v98, v98, s61, v34
    v_mul_f32 v98, s63, v98
    v_mul_f32 v99, v35, v35
    v_mul_f32 v99, v99, v35
    v_fma_f32 v99, v99, s61, v35
    v_mul_f32 v99, s63, v99
    v_mul_f32 v100, v36, v36
    v_mul_f32 v100, v100, v36
    v_fma_f32 v100, v100, s61, v36
    v_mul_f32 v100, s63, v100
    v_mul_f32 v101, v37, v37
    v_mul_f32 v101, v101, v37
    v_fma_f32 v101, v101, s61, v37
    v_mul_f32 v101, s63, v101
    v_mul_f32 v102, v38, v38
    v_mul_f32 v102, v102, v38
    v_fma_f32 v102, v102, s61, v38
    v_mul_f32 v102, s63, v102
    v_mul_f32 v103, v39, v39
    v_mul_f32 v103, v103, v39
    v_fma_f32 v103, v103, s61, v39
    v_mul_f32 v103, s63, v103
    v_exp_f32 v96, v96
    v_exp_f32 v97, v97
    v_exp_f32 v98, v98
    v_exp_f32 v99, v99
    v_exp_f32 v100, v100
    v_exp_f32 v101, v101
    v_exp_f32 v102, v102
    v_exp_f32 v103, v103
    s_nop 0
    v_add_f32 v96, 1.0, v96
    v_add_f32 v97, 1.0, v97
    v_add_f32 v98, 1.0, v98
    v_add_f32 v99, 1.0, v99
    v_add_f32 v100, 1.0, v100
    v_add_f32 v101, 1.0, v101
    v_add_f32 v102, 1.0, v102
    v_add_f32 v103, 1.0, v103
    v_rcp_f32 v96, v96
    v_rcp_f32 v97, v97
    v_rcp_f32 v98, v98
    v_rcp_f32 v99, v99
    v_rcp_f32 v100, v100
    v_rcp_f32 v101, v101
    v_rcp_f32 v102, v102
    v_rcp_f32 v103, v103
    s_nop 0
    v_sub_f32 v96, 1.0, v96
    v_mul_f32 v96, v32, v96
    v_sub_f32 v97, 1.0, v97
    v_mul_f32 v97, v33, v97
    v_sub_f32 v98, 1.0, v98
    v_mul_f32 v98, v34, v98
    v_sub_f32 v99, 1.0, v99
    v_mul_f32 v99, v35, v99
    v_sub_f32 v100, 1.0, v100
    v_mul_f32 v100, v36, v100
    v_sub_f32 v101, 1.0, v101
    v_mul_f32 v101, v37, v101
    v_sub_f32 v102, 1.0, v102
    v_mul_f32 v102, v38, v102
    v_sub_f32 v103, 1.0, v103
    v_mul_f32 v103, v39, v103
    v_cvt_pk_bf16_f32 v104, v96, v97
    v_cvt_pk_bf16_f32 v105, v98, v99
    v_cvt_pk_bf16_f32 v106, v100, v101
    v_cvt_pk_bf16_f32 v107, v102, v103
    v_lshlrev_b32 v96, 16, v104
    v_and_b32 v97, 0xffff0000, v104
    v_lshlrev_b32 v98, 16, v105
    v_and_b32 v99, 0xffff0000, v105
    v_lshlrev_b32 v100, 16, v106
    v_and_b32 v101, 0xffff0000, v106
    v_lshlrev_b32 v102, 16, v107
    v_and_b32 v103, 0xffff0000, v107
    v_mul_f32 v96, v96, v64
    v_mul_f32 v97, v97, v65
    v_mul_f32 v98, v98, v66
    v_mul_f32 v99, v99, v67
    v_mul_f32 v100, v100, v68
    v_mul_f32 v101, v101, v69
    v_mul_f32 v102, v102, v70
    v_mul_f32 v103, v103, v71
    v_cvt_pk_bf16_f32 v104, v96, v97
    v_cvt_pk_bf16_f32 v105, v98, v99
    v_cvt_pk_bf16_f32 v106, v100, v101
    v_cvt_pk_bf16_f32 v107, v102, v103
    v_perm_b32 v32, v104, v126, s20
    v_perm_b32 v33, v104, v126, s21
    v_perm_b32 v34, v105, v126, s22
    v_perm_b32 v35, v105, v126, s23
    v_perm_b32 v36, v106, v126, s20
    v_perm_b32 v37, v106, v126, s21
    v_perm_b32 v38, v107, v126, s22
    v_perm_b32 v39, v107, v126, s23
    v_mov_b32 v10, 133432
    ds_read_b32 v11, v10
    s_waitcnt lgkmcnt(0)
    v_readfirstlane_b32 s31, v11
    s_cmp_eq_u32 s31, 1
    s_cbranch_scc1 L_sl1
    buffer_store_dwordx4 v[32:35], v26, s[16:19], s58 offen offset:0 sc1
    buffer_store_dwordx4 v[36:39], v26, s[16:19], s58 offen offset:1024 sc1
    s_branch L_se1
L_sl1:
    buffer_store_dwordx4 v[32:35], v26, s[16:19], s58 offen offset:0
    buffer_store_dwordx4 v[36:39], v26, s[16:19], s58 offen offset:1024
L_se1:
    s_branch L_Hbar2
L_H2:
    s_getreg_b32 s20, hwreg(HW_REG_XCC_ID, 0, 4)
    s_and_b32 s21, s88, 0xffffff00
    s_or_b32 s21, s21, s20
    v_mov_b32 v8, s21
    s_lshr_b32 s20, s2, 3
    v_lshlrev_b32 v9, 2, v0
    s_lshl_b32 s22, s4, 7
    s_add_u32 s22, s22, 368640
    s_lshl_b64 exec, 1, s20
    buffer_store_dword v8, v9, s[16:19], s22 offen
    s_mov_b64 exec, 0xffffffff
    s_mov_b32 s31, 1
L_wt2:
    s_sleep 2
    s_memrealtime s[90:91]
    s_waitcnt lgkmcnt(0)
    s_sub_u32 s90, s90, s96
    s_cmp_lt_u32 s90, 170
    s_cbranch_scc1 L_wt2
L_hl:
    buffer_load_dword v10, v9, s[16:19], s22 offen nt
    s_memrealtime s[90:91]
    s_waitcnt vmcnt(0) lgkmcnt(0)
    v_cmp_ne_u32 vcc, v10, v8
    s_cbranch_vccz L_hlok
    s_sleep 6
    s_sub_u32 s90, s90, s96
    s_cmp_lt_u32 s90, 330
    s_cbranch_scc1 L_hl
    s_mov_b32 s31, 2
L_hlok:
    s_mov_b64 exec, -1
    v_mov_b32 v8, s31
    v_mov_b32 v9, 133432
    ds_write_b32 v9, v8
    v_lshlrev_b32 v8, 2, v7
    v_add_u32 v8, 133408, v8
    s_sleep 127
    s_sleep 127
    s_sleep 127
    s_sleep 127
    s_cmp_lt_u32 s2, 1
    s_cselect_b64 exec, 1, 0
    v_mov_b32 v9, 0
    v_subrev_u32 v10, 0x1010101, v126
    buffer_store_dword v10, v9, s[16:19], 0 offen offset:0 sc1
    s_mov_b64 exec, -1
    s_mov_b32 s70, 0x10000
L_kd:
    ds_read_b32 v9, v8 offset:0
    s_sub_u32 s70, s70, 1
    s_waitcnt lgkmcnt(0)
    v_cmp_ne_u32 vcc, 1, v9
    s_cbranch_vccz L_kdok
    s_sleep 16
    s_cmp_lg_u32 s70, 0
    s_cbranch_scc1 L_kd
L_kdok:
    v_and_b32 v9, 1, v0
    v_lshlrev_b32 v9, 3, v9
    v_add_u32 v9, 133440, v9
    ds_read_b64 v[12:13], v9 offset:0
    ds_read_b64 v[14:15], v9 offset:16
    ds_read_b64 v[16:17], v9 offset:32
    ds_read_b64 v[18:19], v9 offset:48
    v_lshlrev_b32 v10, 4, v0
    v_add_u32 v10, 24576, v10
    v_add_u32 v11, 0x10000, v10
    ds_read_b128 v[32:35], v10 offset:0
    ds_read_b128 v[36:39], v10 offset:1024
    ds_read_b128 v[40:43], v10 offset:2048
    ds_read_b128 v[44:47], v10 offset:3072
    ds_read_b128 v[48:51], v10 offset:32768
    ds_read_b128 v[52:55], v10 offset:33792
    ds_read_b128 v[56:59], v10 offset:34816
    ds_read_b128 v[60:63], v10 offset:35840
    s_waitcnt lgkmcnt(8)
    ds_read_b128 v[64:67], v11 offset:0
    ds_read_b128 v[68:71], v11 offset:1024
    ds_read_b128 v[72:75], v11 offset:2048
    ds_read_b128 v[76:79], v11 offset:3072
    ds_read_b128 v[80:83], v11 offset:32768
    ds_read_b128 v[84:87], v11 offset:33792
    ds_read_b128 v[88:91], v11 offset:34816
    ds_read_b128 v[92:95], v11 offset:35840
    s_mov_b32 s20, 0x3fb8aa3b
    v_max3_f32 v20, v12, v14, v16
    v_max3_f32 v21, v13, v15, v17
    v_max_f32 v20, v20, v18
    v_max_f32 v21, v21, v19
    v_and_b32 v20, 0xffffff00, v20
    v_and_b32 v21, 0xffffff00, v21
    v_mov_b32 v22, 0
    v_mov_b32 v23, 0
    s_waitcnt lgkmcnt(0)
    v_lshlrev_b32 v24, 16, v32
    v_and_b32 v25, 0xffff0000, v32
    v_lshlrev_b32 v26, 16, v33
    v_and_b32 v27, 0xffff0000, v33
    v_lshlrev_b32 v28, 16, v34
    v_and_b32 v29, 0xffff0000, v34
    v_lshlrev_b32 v30, 16, v35
    v_and_b32 v31, 0xffff0000, v35
    v_fma_f32 v24, v24, s20, -v20
    v_fma_f32 v25, v25, s20, -v20
    v_fma_f32 v26, v26, s20, -v20
    v_fma_f32 v27, v27, s20, -v20
    v_fma_f32 v28, v28, s20, -v21
    v_fma_f32 v29, v29, s20, -v21
    v_fma_f32 v30, v30, s20, -v21
    v_fma_f32 v31, v31, s20, -v21
    v_exp_f32 v24, v24
    v_exp_f32 v25, v25
    v_exp_f32 v26, v26
    v_exp_f32 v27, v27
    v_exp_f32 v28, v28
    v_exp_f32 v29, v29
    v_exp_f32 v30, v30
    v_exp_f32 v31, v31
    s_nop 0
    v_add_f32 v24, v24, v25
    v_add_f32 v26, v26, v27
    v_add_f32 v28, v28, v29
    v_add_f32 v30, v30, v31
    v_add_f32 v24, v24, v26
    v_add_f32 v28, v28, v30
    v_add_f32 v22, v22, v24
    v_add_f32 v23, v23, v28
    v_lshlrev_b32 v24, 16, v36
    v_and_b32 v25, 0xffff0000, v36
    v_lshlrev_b32 v26, 16, v37
    v_and_b32 v27, 0xffff0000, v37
    v_lshlrev_b32 v28, 16, v38
    v_and_b32 v29, 0xffff0000, v38
    v_lshlrev_b32 v30, 16, v39
    v_and_b32 v31, 0xffff0000, v39
    v_fma_f32 v24, v24, s20, -v20
    v_fma_f32 v25, v25, s20, -v20
    v_fma_f32 v26, v26, s20, -v20
    v_fma_f32 v27, v27, s20, -v20
    v_fma_f32 v28, v28, s20, -v21
    v_fma_f32 v29, v29, s20, -v21
    v_fma_f32 v30, v30, s20, -v21
    v_fma_f32 v31, v31, s20, -v21
    v_exp_f32 v24, v24
    v_exp_f32 v25, v25
    v_exp_f32 v26, v26
    v_exp_f32 v27, v27
    v_exp_f32 v28, v28
    v_exp_f32 v29, v29
    v_exp_f32 v30, v30
    v_exp_f32 v31, v31
    s_nop 0
    v_add_f32 v24, v24, v25
    v_add_f32 v26, v26, v27
    v_add_f32 v28, v28, v29
    v_add_f32 v30, v30, v31
    v_add_f32 v24, v24, v26
    v_add_f32 v28, v28, v30
    v_add_f32 v22, v22, v24
    v_add_f32 v23, v23, v28
    v_lshlrev_b32 v24, 16, v40
    v_and_b32 v25, 0xffff0000, v40
    v_lshlrev_b32 v26, 16, v41
    v_and_b32 v27, 0xffff0000, v41
    v_lshlrev_b32 v28, 16, v42
    v_and_b32 v29, 0xffff0000, v42
    v_lshlrev_b32 v30, 16, v43
    v_and_b32 v31, 0xffff0000, v43
    v_fma_f32 v24, v24, s20, -v20
    v_fma_f32 v25, v25, s20, -v20
    v_fma_f32 v26, v26, s20, -v20
    v_fma_f32 v27, v27, s20, -v20
    v_fma_f32 v28, v28, s20, -v21
    v_fma_f32 v29, v29, s20, -v21
    v_fma_f32 v30, v30, s20, -v21
    v_fma_f32 v31, v31, s20, -v21
    v_exp_f32 v24, v24
    v_exp_f32 v25, v25
    v_exp_f32 v26, v26
    v_exp_f32 v27, v27
    v_exp_f32 v28, v28
    v_exp_f32 v29, v29
    v_exp_f32 v30, v30
    v_exp_f32 v31, v31
    s_nop 0
    v_add_f32 v24, v24, v25
    v_add_f32 v26, v26, v27
    v_add_f32 v28, v28, v29
    v_add_f32 v30, v30, v31
    v_add_f32 v24, v24, v26
    v_add_f32 v28, v28, v30
    v_add_f32 v22, v22, v24
    v_add_f32 v23, v23, v28
    v_lshlrev_b32 v24, 16, v44
    v_and_b32 v25, 0xffff0000, v44
    v_lshlrev_b32 v26, 16, v45
    v_and_b32 v27, 0xffff0000, v45
    v_lshlrev_b32 v28, 16, v46
    v_and_b32 v29, 0xffff0000, v46
    v_lshlrev_b32 v30, 16, v47
    v_and_b32 v31, 0xffff0000, v47
    v_fma_f32 v24, v24, s20, -v20
    v_fma_f32 v25, v25, s20, -v20
    v_fma_f32 v26, v26, s20, -v20
    v_fma_f32 v27, v27, s20, -v20
    v_fma_f32 v28, v28, s20, -v21
    v_fma_f32 v29, v29, s20, -v21
    v_fma_f32 v30, v30, s20, -v21
    v_fma_f32 v31, v31, s20, -v21
    v_exp_f32 v24, v24
    v_exp_f32 v25, v25
    v_exp_f32 v26, v26
    v_exp_f32 v27, v27
    v_exp_f32 v28, v28
    v_exp_f32 v29, v29
    v_exp_f32 v30, v30
    v_exp_f32 v31, v31
    s_nop 0
    v_add_f32 v24, v24, v25
    v_add_f32 v26, v26, v27
    v_add_f32 v28, v28, v29
    v_add_f32 v30, v30, v31
    v_add_f32 v24, v24, v26
    v_add_f32 v28, v28, v30
    v_add_f32 v22, v22, v24
    v_add_f32 v23, v23, v28
    v_lshlrev_b32 v24, 16, v48
    v_and_b32 v25, 0xffff0000, v48
    v_lshlrev_b32 v26, 16, v49
    v_and_b32 v27, 0xffff0000, v49
    v_lshlrev_b32 v28, 16, v50
    v_and_b32 v29, 0xffff0000, v50
    v_lshlrev_b32 v30, 16, v51
    v_and_b32 v31, 0xffff0000, v51
    v_fma_f32 v24, v24, s20, -v20
    v_fma_f32 v25, v25, s20, -v20
    v_fma_f32 v26, v26, s20, -v20
    v_fma_f32 v27, v27, s20, -v20
    v_fma_f32 v28, v28, s20, -v21
    v_fma_f32 v29, v29, s20, -v21
    v_fma_f32 v30, v30, s20, -v21
    v_fma_f32 v31, v31, s20, -v21
    v_exp_f32 v24, v24
    v_exp_f32 v25, v25
    v_exp_f32 v26, v26
    v_exp_f32 v27, v27
    v_exp_f32 v28, v28
    v_exp_f32 v29, v29
    v_exp_f32 v30, v30
    v_exp_f32 v31, v31
    s_nop 0
    v_add_f32 v24, v24, v25
    v_add_f32 v26, v26, v27
    v_add_f32 v28, v28, v29
    v_add_f32 v30, v30, v31
    v_add_f32 v24, v24, v26
    v_add_f32 v28, v28, v30
    v_add_f32 v22, v22, v24
    v_add_f32 v23, v23, v28
    v_lshlrev_b32 v24, 16, v52
    v_and_b32 v25, 0xffff0000, v52
    v_lshlrev_b32 v26, 16, v53
    v_and_b32 v27, 0xffff0000, v53
    v_lshlrev_b32 v28, 16, v54
    v_and_b32 v29, 0xffff0000, v54
    v_lshlrev_b32 v30, 16, v55
    v_and_b32 v31, 0xffff0000, v55
    v_fma_f32 v24, v24, s20, -v20
    v_fma_f32 v25, v25, s20, -v20
    v_fma_f32 v26, v26, s20, -v20
    v_fma_f32 v27, v27, s20, -v20
    v_fma_f32 v28, v28, s20, -v21
    v_fma_f32 v29, v29, s20, -v21
    v_fma_f32 v30, v30, s20, -v21
    v_fma_f32 v31, v31, s20, -v21
    v_exp_f32 v24, v24
    v_exp_f32 v25, v25
    v_exp_f32 v26, v26
    v_exp_f32 v27, v27
    v_exp_f32 v28, v28
    v_exp_f32 v29, v29
    v_exp_f32 v30, v30
    v_exp_f32 v31, v31
    s_nop 0
    v_add_f32 v24, v24, v25
    v_add_f32 v26, v26, v27
    v_add_f32 v28, v28, v29
    v_add_f32 v30, v30, v31
    v_add_f32 v24, v24, v26
    v_add_f32 v28, v28, v30
    v_add_f32 v22, v22, v24
    v_add_f32 v23, v23, v28
    v_lshlrev_b32 v24, 16, v56
    v_and_b32 v25, 0xffff0000, v56
    v_lshlrev_b32 v26, 16, v57
    v_and_b32 v27, 0xffff0000, v57
    v_lshlrev_b32 v28, 16, v58
    v_and_b32 v29, 0xffff0000, v58
    v_lshlrev_b32 v30, 16, v59
    v_and_b32 v31, 0xffff0000, v59
    v_fma_f32 v24, v24, s20, -v20
    v_fma_f32 v25, v25, s20, -v20
    v_fma_f32 v26, v26, s20, -v20
    v_fma_f32 v27, v27, s20, -v20
    v_fma_f32 v28, v28, s20, -v21
    v_fma_f32 v29, v29, s20, -v21
    v_fma_f32 v30, v30, s20, -v21
    v_fma_f32 v31, v31, s20, -v21
    v_exp_f32 v24, v24
    v_exp_f32 v25, v25
    v_exp_f32 v26, v26
    v_exp_f32 v27, v27
    v_exp_f32 v28, v28
    v_exp_f32 v29, v29
    v_exp_f32 v30, v30
    v_exp_f32 v31, v31
    s_nop 0
    v_add_f32 v24, v24, v25
    v_add_f32 v26, v26, v27
    v_add_f32 v28, v28, v29
    v_add_f32 v30, v30, v31
    v_add_f32 v24, v24, v26
    v_add_f32 v28, v28, v30
    v_add_f32 v22, v22, v24
    v_add_f32 v23, v23, v28
    v_lshlrev_b32 v24, 16, v60
    v_and_b32 v25, 0xffff0000, v60
    v_lshlrev_b32 v26, 16, v61
    v_and_b32 v27, 0xffff0000, v61
    v_lshlrev_b32 v28, 16, v62
    v_and_b32 v29, 0xffff0000, v62
    v_lshlrev_b32 v30, 16, v63
    v_and_b32 v31, 0xffff0000, v63
    v_fma_f32 v24, v24, s20, -v20
    v_fma_f32 v25, v25, s20, -v20
    v_fma_f32 v26, v26, s20, -v20
    v_fma_f32 v27, v27, s20, -v20
    v_fma_f32 v28, v28, s20, -v21
    v_fma_f32 v29, v29, s20, -v21
    v_fma_f32 v30, v30, s20, -v21
    v_fma_f32 v31, v31, s20, -v21
    v_exp_f32 v24, v24
    v_exp_f32 v25, v25
    v_exp_f32 v26, v26
    v_exp_f32 v27, v27
    v_exp_f32 v28, v28
    v_exp_f32 v29, v29
    v_exp_f32 v30, v30
    v_exp_f32 v31, v31
    s_nop 0
    v_add_f32 v24, v24, v25
    v_add_f32 v26, v26, v27
    v_add_f32 v28, v28, v29
    v_add_f32 v30, v30, v31
    v_add_f32 v24, v24, v26
    v_add_f32 v28, v28, v30
    v_add_f32 v22, v22, v24
    v_add_f32 v23, v23, v28
    v_lshlrev_b32 v24, 16, v64
    v_and_b32 v25, 0xffff0000, v64
    v_lshlrev_b32 v26, 16, v65
    v_and_b32 v27, 0xffff0000, v65
    v_lshlrev_b32 v28, 16, v66
    v_and_b32 v29, 0xffff0000, v66
    v_lshlrev_b32 v30, 16, v67
    v_and_b32 v31, 0xffff0000, v67
    v_fma_f32 v24, v24, s20, -v20
    v_fma_f32 v25, v25, s20, -v20
    v_fma_f32 v26, v26, s20, -v20
    v_fma_f32 v27, v27, s20, -v20
    v_fma_f32 v28, v28, s20, -v21
    v_fma_f32 v29, v29, s20, -v21
    v_fma_f32 v30, v30, s20, -v21
    v_fma_f32 v31, v31, s20, -v21
    v_exp_f32 v24, v24
    v_exp_f32 v25, v25
    v_exp_f32 v26, v26
    v_exp_f32 v27, v27
    v_exp_f32 v28, v28
    v_exp_f32 v29, v29
    v_exp_f32 v30, v30
    v_exp_f32 v31, v31
    s_nop 0
    v_add_f32 v24, v24, v25
    v_add_f32 v26, v26, v27
    v_add_f32 v28, v28, v29
    v_add_f32 v30, v30, v31
    v_add_f32 v24, v24, v26
    v_add_f32 v28, v28, v30
    v_add_f32 v22, v22, v24
    v_add_f32 v23, v23, v28
    v_lshlrev_b32 v24, 16, v68
    v_and_b32 v25, 0xffff0000, v68
    v_lshlrev_b32 v26, 16, v69
    v_and_b32 v27, 0xffff0000, v69
    v_lshlrev_b32 v28, 16, v70
    v_and_b32 v29, 0xffff0000, v70
    v_lshlrev_b32 v30, 16, v71
    v_and_b32 v31, 0xffff0000, v71
    v_fma_f32 v24, v24, s20, -v20
    v_fma_f32 v25, v25, s20, -v20
    v_fma_f32 v26, v26, s20, -v20
    v_fma_f32 v27, v27, s20, -v20
    v_fma_f32 v28, v28, s20, -v21
    v_fma_f32 v29, v29, s20, -v21
    v_fma_f32 v30, v30, s20, -v21
    v_fma_f32 v31, v31, s20, -v21
    v_exp_f32 v24, v24
    v_exp_f32 v25, v25
    v_exp_f32 v26, v26
    v_exp_f32 v27, v27
    v_exp_f32 v28, v28
    v_exp_f32 v29, v29
    v_exp_f32 v30, v30
    v_exp_f32 v31, v31
    s_nop 0
    v_add_f32 v24, v24, v25
    v_add_f32 v26, v26, v27
    v_add_f32 v28, v28, v29
    v_add_f32 v30, v30, v31
    v_add_f32 v24, v24, v26
    v_add_f32 v28, v28, v30
    v_add_f32 v22, v22, v24
    v_add_f32 v23, v23, v28
    v_lshlrev_b32 v24, 16, v72
    v_and_b32 v25, 0xffff0000, v72
    v_lshlrev_b32 v26, 16, v73
    v_and_b32 v27, 0xffff0000, v73
    v_lshlrev_b32 v28, 16, v74
    v_and_b32 v29, 0xffff0000, v74
    v_lshlrev_b32 v30, 16, v75
    v_and_b32 v31, 0xffff0000, v75
    v_fma_f32 v24, v24, s20, -v20
    v_fma_f32 v25, v25, s20, -v20
    v_fma_f32 v26, v26, s20, -v20
    v_fma_f32 v27, v27, s20, -v20
    v_fma_f32 v28, v28, s20, -v21
    v_fma_f32 v29, v29, s20, -v21
    v_fma_f32 v30, v30, s20, -v21
    v_fma_f32 v31, v31, s20, -v21
    v_exp_f32 v24, v24
    v_exp_f32 v25, v25
    v_exp_f32 v26, v26
    v_exp_f32 v27, v27
    v_exp_f32 v28, v28
    v_exp_f32 v29, v29
    v_exp_f32 v30, v30
    v_exp_f32 v31, v31
    s_nop 0
    v_add_f32 v24, v24, v25
    v_add_f32 v26, v26, v27
    v_add_f32 v28, v28, v29
    v_add_f32 v30, v30, v31
    v_add_f32 v24, v24, v26
    v_add_f32 v28, v28, v30
    v_add_f32 v22, v22, v24
    v_add_f32 v23, v23, v28
    v_lshlrev_b32 v24, 16, v76
    v_and_b32 v25, 0xffff0000, v76
    v_lshlrev_b32 v26, 16, v77
    v_and_b32 v27, 0xffff0000, v77
    v_lshlrev_b32 v28, 16, v78
    v_and_b32 v29, 0xffff0000, v78
    v_lshlrev_b32 v30, 16, v79
    v_and_b32 v31, 0xffff0000, v79
    v_fma_f32 v24, v24, s20, -v20
    v_fma_f32 v25, v25, s20, -v20
    v_fma_f32 v26, v26, s20, -v20
    v_fma_f32 v27, v27, s20, -v20
    v_fma_f32 v28, v28, s20, -v21
    v_fma_f32 v29, v29, s20, -v21
    v_fma_f32 v30, v30, s20, -v21
    v_fma_f32 v31, v31, s20, -v21
    v_exp_f32 v24, v24
    v_exp_f32 v25, v25
    v_exp_f32 v26, v26
    v_exp_f32 v27, v27
    v_exp_f32 v28, v28
    v_exp_f32 v29, v29
    v_exp_f32 v30, v30
    v_exp_f32 v31, v31
    s_nop 0
    v_add_f32 v24, v24, v25
    v_add_f32 v26, v26, v27
    v_add_f32 v28, v28, v29
    v_add_f32 v30, v30, v31
    v_add_f32 v24, v24, v26
    v_add_f32 v28, v28, v30
    v_add_f32 v22, v22, v24
    v_add_f32 v23, v23, v28
    v_lshlrev_b32 v24, 16, v80
    v_and_b32 v25, 0xffff0000, v80
    v_lshlrev_b32 v26, 16, v81
    v_and_b32 v27, 0xffff0000, v81
    v_lshlrev_b32 v28, 16, v82
    v_and_b32 v29, 0xffff0000, v82
    v_lshlrev_b32 v30, 16, v83
    v_and_b32 v31, 0xffff0000, v83
    v_fma_f32 v24, v24, s20, -v20
    v_fma_f32 v25, v25, s20, -v20
    v_fma_f32 v26, v26, s20, -v20
    v_fma_f32 v27, v27, s20, -v20
    v_fma_f32 v28, v28, s20, -v21
    v_fma_f32 v29, v29, s20, -v21
    v_fma_f32 v30, v30, s20, -v21
    v_fma_f32 v31, v31, s20, -v21
    v_exp_f32 v24, v24
    v_exp_f32 v25, v25
    v_exp_f32 v26, v26
    v_exp_f32 v27, v27
    v_exp_f32 v28, v28
    v_exp_f32 v29, v29
    v_exp_f32 v30, v30
    v_exp_f32 v31, v31
    s_nop 0
    v_add_f32 v24, v24, v25
    v_add_f32 v26, v26, v27
    v_add_f32 v28, v28, v29
    v_add_f32 v30, v30, v31
    v_add_f32 v24, v24, v26
    v_add_f32 v28, v28, v30
    v_add_f32 v22, v22, v24
    v_add_f32 v23, v23, v28
    v_lshlrev_b32 v24, 16, v84
    v_and_b32 v25, 0xffff0000, v84
    v_lshlrev_b32 v26, 16, v85
    v_and_b32 v27, 0xffff0000, v85
    v_lshlrev_b32 v28, 16, v86
    v_and_b32 v29, 0xffff0000, v86
    v_lshlrev_b32 v30, 16, v87
    v_and_b32 v31, 0xffff0000, v87
    v_fma_f32 v24, v24, s20, -v20
    v_fma_f32 v25, v25, s20, -v20
    v_fma_f32 v26, v26, s20, -v20
    v_fma_f32 v27, v27, s20, -v20
    v_fma_f32 v28, v28, s20, -v21
    v_fma_f32 v29, v29, s20, -v21
    v_fma_f32 v30, v30, s20, -v21
    v_fma_f32 v31, v31, s20, -v21
    v_exp_f32 v24, v24
    v_exp_f32 v25, v25
    v_exp_f32 v26, v26
    v_exp_f32 v27, v27
    v_exp_f32 v28, v28
    v_exp_f32 v29, v29
    v_exp_f32 v30, v30
    v_exp_f32 v31, v31
    s_nop 0
    v_add_f32 v24, v24, v25
    v_add_f32 v26, v26, v27
    v_add_f32 v28, v28, v29
    v_add_f32 v30, v30, v31
    v_add_f32 v24, v24, v26
    v_add_f32 v28, v28, v30
    v_add_f32 v22, v22, v24
    v_add_f32 v23, v23, v28
    v_lshlrev_b32 v24, 16, v88
    v_and_b32 v25, 0xffff0000, v88
    v_lshlrev_b32 v26, 16, v89
    v_and_b32 v27, 0xffff0000, v89
    v_lshlrev_b32 v28, 16, v90
    v_and_b32 v29, 0xffff0000, v90
    v_lshlrev_b32 v30, 16, v91
    v_and_b32 v31, 0xffff0000, v91
    v_fma_f32 v24, v24, s20, -v20
    v_fma_f32 v25, v25, s20, -v20
    v_fma_f32 v26, v26, s20, -v20
    v_fma_f32 v27, v27, s20, -v20
    v_fma_f32 v28, v28, s20, -v21
    v_fma_f32 v29, v29, s20, -v21
    v_fma_f32 v30, v30, s20, -v21
    v_fma_f32 v31, v31, s20, -v21
    v_exp_f32 v24, v24
    v_exp_f32 v25, v25
    v_exp_f32 v26, v26
    v_exp_f32 v27, v27
    v_exp_f32 v28, v28
    v_exp_f32 v29, v29
    v_exp_f32 v30, v30
    v_exp_f32 v31, v31
    s_nop 0
    v_add_f32 v24, v24, v25
    v_add_f32 v26, v26, v27
    v_add_f32 v28, v28, v29
    v_add_f32 v30, v30, v31
    v_add_f32 v24, v24, v26
    v_add_f32 v28, v28, v30
    v_add_f32 v22, v22, v24
    v_add_f32 v23, v23, v28
    v_lshlrev_b32 v24, 16, v92
    v_and_b32 v25, 0xffff0000, v92
    v_lshlrev_b32 v26, 16, v93
    v_and_b32 v27, 0xffff0000, v93
    v_lshlrev_b32 v28, 16, v94
    v_and_b32 v29, 0xffff0000, v94
    v_lshlrev_b32 v30, 16, v95
    v_and_b32 v31, 0xffff0000, v95
    v_fma_f32 v24, v24, s20, -v20
    v_fma_f32 v25, v25, s20, -v20
    v_fma_f32 v26, v26, s20, -v20
    v_fma_f32 v27, v27, s20, -v20
    v_fma_f32 v28, v28, s20, -v21
    v_fma_f32 v29, v29, s20, -v21
    v_fma_f32 v30, v30, s20, -v21
    v_fma_f32 v31, v31, s20, -v21
    v_exp_f32 v24, v24
    v_exp_f32 v25, v25
    v_exp_f32 v26, v26
    v_exp_f32 v27, v27
    v_exp_f32 v28, v28
    v_exp_f32 v29, v29
    v_exp_f32 v30, v30
    v_exp_f32 v31, v31
    s_nop 0
    v_add_f32 v24, v24, v25
    v_add_f32 v26, v26, v27
    v_add_f32 v28, v28, v29
    v_add_f32 v30, v30, v31
    v_add_f32 v24, v24, v26
    v_add_f32 v28, v28, v30
    v_add_f32 v22, v22, v24
    v_add_f32 v23, v23, v28
    s_nop 0
    v_add_f32_dpp v24, v22, v22 row_ror:2 row_mask:0xf bank_mask:0xf
    v_add_f32_dpp v25, v23, v23 row_ror:2 row_mask:0xf bank_mask:0xf
    v_mov_b32 v22, v24
    v_mov_b32 v23, v25
    s_nop 0
    v_add_f32_dpp v24, v22, v22 row_ror:4 row_mask:0xf bank_mask:0xf
    v_add_f32_dpp v25, v23, v23 row_ror:4 row_mask:0xf bank_mask:0xf
    v_mov_b32 v22, v24
    v_mov_b32 v23, v25
    s_nop 0
    v_add_f32_dpp v24, v22, v22 row_ror:8 row_mask:0xf bank_mask:0xf
    v_add_f32_dpp v25, v23, v23 row_ror:8 row_mask:0xf bank_mask:0xf
    v_mov_b32 v22, v24
    v_mov_b32 v23, v25
    s_nop 0
    v_permlane16_swap_b32 v22, v24
    v_permlane16_swap_b32 v23, v25
    v_add_f32 v22, v22, v24
    v_add_f32 v23, v23, v25
    v_mov_b32 v24, v22
    v_mov_b32 v25, v23
    s_nop 0
    v_permlane32_swap_b32 v22, v24
    v_permlane32_swap_b32 v23, v25
    v_add_f32 v22, v22, v24
    v_add_f32 v23, v23, v25
    v_mov_b32 v24, v22
    v_mov_b32 v25, v23
    v_perm_b32 v24, v20, v126, s92
    v_perm_b32 v25, v22, v126, s93
    v_perm_b32 v26, v21, v126, s94
    v_perm_b32 v27, v23, v126, s95
    s_lshl_b32 s58, s89, 8
    s_add_u32 s58, s58, 393216
    s_lshl_b32 s59, s7, 6
    s_add_u32 s59, s59, s58
    v_lshlrev_b32 v8, 4, v7
    s_mov_b64 exec, 15
    s_cmp_eq_u32 s31, 1
    s_cbranch_scc1 L_sl2
    buffer_store_dwordx4 v[24:27], v8, s[16:19], s59 offen sc1
    s_branch L_se2
L_sl2:
    buffer_store_dwordx4 v[24:27], v8, s[16:19], s59 offen
L_se2:
    s_mov_b64 exec, 0xff
    v_lshrrev_b32 v8, 1, v0
    v_lshlrev_b32 v8, 6, v8
    v_lshl_add_u32 v8, v9, 1, v8
    v_subrev_u32 v8, 266880, v8
    s_mov_b32 s70, 0x8000
    s_sleep 52
L_mpn:
    s_sleep 48
    buffer_load_dwordx4 v[24:27], v8, s[16:19], s58 offen nt
    s_branch L_mpc
L_mp:
    s_sleep 48
    buffer_load_dwordx4 v[24:27], v8, s[16:19], s58 offen sc1
L_mpc:
    s_sub_u32 s70, s70, 1
    s_waitcnt vmcnt(0)
    v_perm_b32 v29, v25, v24, s64
    v_perm_b32 v30, v27, v26, s65
    v_or_b32 v28, v29, v30
    v_xor_b32 v28, v126, v28
    v_cmp_ne_u32 vcc, 0, v28
    s_cbranch_vccz L_mpok
    s_bitcmp0_b32 s70, 0
    s_cbranch_scc1 L_mpn
    s_cmp_gt_u32 s70, 1
    s_cbranch_scc1 L_mp
L_mpok:
    v_and_b32 v24, 0xffffff00, v24
    v_and_b32 v26, 0xffffff00, v26
    s_nop 1
    v_max_f32_dpp v30, v24, v24 quad_perm:[2,3,0,1] row_mask:0xf bank_mask:0xf
    s_nop 1
    v_mov_b32_dpp v28, v30 row_half_mirror row_mask:0xf bank_mask:0xf
    s_nop 1
    v_max_f32_dpp v28, v28, v30 quad_perm:[1,0,3,2] row_mask:0xf bank_mask:0xf
    s_nop 1
    v_max_f32_dpp v30, v26, v26 quad_perm:[2,3,0,1] row_mask:0xf bank_mask:0xf
    s_nop 1
    v_mov_b32_dpp v29, v30 row_half_mirror row_mask:0xf bank_mask:0xf
    s_nop 1
    v_max_f32_dpp v29, v29, v30 quad_perm:[1,0,3,2] row_mask:0xf bank_mask:0xf
    v_sub_f32 v24, v24, v28
    v_sub_f32 v26, v26, v29
    v_exp_f32 v24, v24
    v_exp_f32 v26, v26
    s_nop 0
    v_mul_f32 v24, v24, v25
    v_mul_f32 v26, v26, v27
    s_nop 1
    v_add_f32_dpp v30, v24, v24 quad_perm:[2,3,0,1] row_mask:0xf bank_mask:0xf
    s_nop 1
    v_mov_b32_dpp v22, v30 row_half_mirror row_mask:0xf bank_mask:0xf
    s_nop 1
    v_add_f32_dpp v22, v22, v30 quad_perm:[1,0,3,2] row_mask:0xf bank_mask:0xf
    s_nop 1
    v_add_f32_dpp v30, v26, v26 quad_perm:[2,3,0,1] row_mask:0xf bank_mask:0xf
    s_nop 1
    v_mov_b32_dpp v23, v30 row_half_mirror row_mask:0xf bank_mask:0xf
    s_nop 1
    v_add_f32_dpp v23, v23, v30 quad_perm:[1,0,3,2] row_mask:0xf bank_mask:0xf
    v_rcp_f32 v22, v22
    v_rcp_f32 v23, v23
    v_sub_f32 v32, v12, v28
    v_sub_f32 v36, v13, v29
    v_sub_f32 v33, v14, v28
    v_sub_f32 v37, v15, v29
    v_sub_f32 v34, v16, v28
    v_sub_f32 v38, v17, v29
    v_sub_f32 v35, v18, v28
    v_sub_f32 v39, v19, v29
    v_exp_f32 v32, v32
    v_exp_f32 v33, v33
    v_exp_f32 v34, v34
    v_exp_f32 v35, v35
    v_exp_f32 v36, v36
    v_exp_f32 v37, v37
    v_exp_f32 v38, v38
    v_exp_f32 v39, v39
    s_nop 0
    v_mul_f32 v32, v32, v22
    v_mul_f32 v33, v33, v22
    v_mul_f32 v34, v34, v22
    v_mul_f32 v35, v35, v22
    v_mul_f32 v36, v36, v23
    v_mul_f32 v37, v37, v23
    v_mul_f32 v38, v38, v23
    v_mul_f32 v39, v39, v23
    v_and_b32 v9, 1, v0
    v_lshlrev_b32 v9, 5, v9
    v_add_u32 v9, 133504, v9
    s_mov_b64 exec, 3
    ds_write_b128 v9, v[32:35]
    ds_write_b128 v9, v[36:39] offset:16
    s_mov_b64 exec, -1
    s_waitcnt lgkmcnt(0)
    s_branch L_Hbar2
L_H1:
    s_load_dword s88, s[56:57], 0
    v_and_b32 v2, 15, v0
    v_lshrrev_b32 v6, 2, v2
    v_lshl_add_u32 v6, v3, 3, v6
    v_lshlrev_b32 v6, 7, v6
    v_and_b32 v7, 3, v0
    v_lshl_add_u32 v6, v7, 3, v6
    s_mov_b32 s92, 0x7060500
    s_mov_b32 s93, 0x7060501
    s_mov_b32 s94, 0x7060502
    s_mov_b32 s95, 0x7060503
    s_mov_b32 s64, 0x0c0c0400
    s_mov_b32 s65, 0x04000c0c
    s_mov_b32 s16, s56
    s_and_b32 s17, s57, 0xffff
    s_mov_b32 s18, 0x1000000
    s_mov_b32 s19, 0x20000
    v_add_u32 v9, 135168, v6
    v_bfe_u32 v10, v0, 3, 1
    v_lshlrev_b32 v10, 6, v10
    v_lshl_add_u32 v10, v3, 4, v10
    v_lshl_add_u32 v11, v5, 4, v10
    v_lshl_add_u32 v10, v5, 12, v10
    s_lshl2_add_u32 s58, s4, s7
    s_lshl3_add_u32 s58, s58, s6
    s_lshl_b32 s58, s58, 8
    s_add_u32 s58, s58, 1048576
    s_mov_b32 s62, 0xff00ff00
    s_mov_b32 s63, 0xff00ff00
    s_waitcnt lgkmcnt(0)
    s_add_u32 s88, s88, 0x1010101
    v_mov_b32 v126, s88
    v_lshl_add_u32 v15, v4, 10, v5
    v_lshlrev_b32 v14, 4, v0
    v_add_u32 v14, 135168, v14
    v_xor_b32 v126, 0x80808080, v126
    s_waitcnt vmcnt(12)
    ds_read_b64_tr_b16 v[48:49], v9 offset:0
    ds_read_b64_tr_b16 v[50:51], v9 offset:512
    ds_read_b64_tr_b16 v[52:53], v9 offset:32
    ds_read_b64_tr_b16 v[54:55], v9 offset:544
    ds_read_b64_tr_b16 v[56:57], v9 offset:64
    ds_read_b64_tr_b16 v[58:59], v9 offset:576
    ds_read_b64_tr_b16 v[60:61], v9 offset:96
    ds_read_b64_tr_b16 v[62:63], v9 offset:608
    s_waitcnt lgkmcnt(6)
    v_mfma_f32_16x16x32_bf16 v[32:35], v[48:51], v[16:19], 0
    s_waitcnt lgkmcnt(4)
    v_mfma_f32_16x16x32_bf16 v[36:39], v[52:55], v[16:19], 0
    s_waitcnt lgkmcnt(2)
    v_mfma_f32_16x16x32_bf16 v[40:43], v[56:59], v[16:19], 0
    s_waitcnt lgkmcnt(0)
    v_mfma_f32_16x16x32_bf16 v[44:47], v[60:63], v[16:19], 0
    s_waitcnt vmcnt(8)
    ds_read_b64_tr_b16 v[64:65], v9 offset:4096
    ds_read_b64_tr_b16 v[66:67], v9 offset:4608
    ds_read_b64_tr_b16 v[68:69], v9 offset:4128
    ds_read_b64_tr_b16 v[70:71], v9 offset:4640
    ds_read_b64_tr_b16 v[72:73], v9 offset:4160
    ds_read_b64_tr_b16 v[74:75], v9 offset:4672
    ds_read_b64_tr_b16 v[76:77], v9 offset:4192
    ds_read_b64_tr_b16 v[78:79], v9 offset:4704
    s_waitcnt lgkmcnt(6)
    v_mfma_f32_16x16x32_bf16 v[32:35], v[64:67], v[20:23], v[32:35]
    s_waitcnt lgkmcnt(4)
    v_mfma_f32_16x16x32_bf16 v[36:39], v[68:71], v[20:23], v[36:39]
    s_waitcnt lgkmcnt(2)
    v_mfma_f32_16x16x32_bf16 v[40:43], v[72:75], v[20:23], v[40:43]
    s_waitcnt lgkmcnt(0)
    v_mfma_f32_16x16x32_bf16 v[44:47], v[76:79], v[20:23], v[44:47]
    s_waitcnt vmcnt(4)
    ds_read_b64_tr_b16 v[48:49], v9 offset:8192
    ds_read_b64_tr_b16 v[50:51], v9 offset:8704
    ds_read_b64_tr_b16 v[52:53], v9 offset:8224
    ds_read_b64_tr_b16 v[54:55], v9 offset:8736
    ds_read_b64_tr_b16 v[56:57], v9 offset:8256
    ds_read_b64_tr_b16 v[58:59], v9 offset:8768
    ds_read_b64_tr_b16 v[60:61], v9 offset:8288
    ds_read_b64_tr_b16 v[62:63], v9 offset:8800
    s_waitcnt lgkmcnt(6)
    v_mfma_f32_16x16x32_bf16 v[32:35], v[48:51], v[24:27], v[32:35]
    s_waitcnt lgkmcnt(4)
    v_mfma_f32_16x16x32_bf16 v[36:39], v[52:55], v[24:27], v[36:39]
    s_waitcnt lgkmcnt(2)
    v_mfma_f32_16x16x32_bf16 v[40:43], v[56:59], v[24:27], v[40:43]
    s_waitcnt lgkmcnt(0)
    v_mfma_f32_16x16x32_bf16 v[44:47], v[60:63], v[24:27], v[44:47]
    s_waitcnt vmcnt(0)
    ds_read_b64_tr_b16 v[64:65], v9 offset:12288
    ds_read_b64_tr_b16 v[66:67], v9 offset:12800
    ds_read_b64_tr_b16 v[68:69], v9 offset:12320
    ds_read_b64_tr_b16 v[70:71], v9 offset:12832
    ds_read_b64_tr_b16 v[72:73], v9 offset:12352
    ds_read_b64_tr_b16 v[74:75], v9 offset:12864
    ds_read_b64_tr_b16 v[76:77], v9 offset:12384
    ds_read_b64_tr_b16 v[78:79], v9 offset:12896
    s_waitcnt lgkmcnt(6)
    v_mfma_f32_16x16x32_bf16 v[32:35], v[64:67], v[28:31], v[32:35]
    s_waitcnt lgkmcnt(4)
    v_mfma_f32_16x16x32_bf16 v[36:39], v[68:71], v[28:31], v[36:39]
    s_waitcnt lgkmcnt(2)
    v_mfma_f32_16x16x32_bf16 v[40:43], v[72:75], v[28:31], v[40:43]
    s_waitcnt lgkmcnt(0)
    v_mfma_f32_16x16x32_bf16 v[44:47], v[76:79], v[28:31], v[44:47]
    s_nop 7
    s_nop 0
    v_cndmask_b32 v48, v32, v36, s[62:63]
    v_cndmask_b32 v49, v33, v37, s[62:63]
    v_cndmask_b32 v50, v34, v38, s[62:63]
    v_cndmask_b32 v51, v35, v39, s[62:63]
    v_perm_b32 v48, v48, v126, s92
    v_perm_b32 v49, v49, v126, s93
    v_perm_b32 v50, v50, v126, s94
    v_perm_b32 v51, v51, v126, s95
    v_cndmask_b32 v52, v40, v44, s[62:63]
    v_cndmask_b32 v53, v41, v45, s[62:63]
    v_cndmask_b32 v54, v42, v46, s[62:63]
    v_cndmask_b32 v55, v43, v47, s[62:63]
    v_perm_b32 v52, v52, v126, s92
    v_perm_b32 v53, v53, v126, s93
    v_perm_b32 v54, v54, v126, s94
    v_perm_b32 v55, v55, v126, s95
    v_xor_b32 v126, 0x80808080, v126
    s_mov_b32 s66, s58
    s_lshr_b32 s23, s6, 2
    s_lshl3_add_u32 s23, s23, s4
    s_and_b32 s20, s6, 3
    s_lshl2_add_u32 s23, s23, s20
    s_cmp_ge_u32 s23, 56
    s_cbranch_scc1 L_H1a
    s_movk_i32 s20, 3584
    v_mul_u32_u24 v8, s20, v4
    v_add_u32 v8, v8, v5
    s_mul_i32 s59, s7, 458752
    s_lshr_b32 s20, s23, 1
    s_lshl_b32 s20, s20, 7
    s_add_u32 s59, s59, s20
    s_bitcmp1_b32 s23, 0
    s_cselect_b32 s24, s46, s44
    s_cselect_b32 s25, s47, s45
    s_and_b32 s25, s25, 0xffff
    s_mov_b32 s26, 0x1c0000
L_wt3:
    s_sleep 1
    s_memrealtime s[90:91]
    s_waitcnt lgkmcnt(0)
    s_sub_u32 s90, s90, s96
    s_cmp_lt_u32 s90, 210
    s_cbranch_scc1 L_wt3
    s_mov_b32 m0, 135168
    buffer_load_dwordx4 v8, s[24:27], s59 offen nt lds
    s_add_u32 s59, s59, 28672
    s_mov_b32 m0, 136192
    buffer_load_dwordx4 v8, s[24:27], s59 offen nt lds
    s_add_u32 s59, s59, 28672
    s_mov_b32 m0, 137216
    buffer_load_dwordx4 v8, s[24:27], s59 offen nt lds
    s_add_u32 s59, s59, 28672
    s_mov_b32 m0, 138240
    buffer_load_dwordx4 v8, s[24:27], s59 offen nt lds
    s_add_u32 s59, s59, 28672
    s_mov_b32 m0, 139264
    buffer_load_dwordx4 v8, s[24:27], s59 offen nt lds
    s_add_u32 s59, s59, 28672
    s_mov_b32 m0, 140288
    buffer_load_dwordx4 v8, s[24:27], s59 offen nt lds
    s_add_u32 s59, s59, 28672
    s_mov_b32 m0, 141312
    buffer_load_dwordx4 v8, s[24:27], s59 offen nt lds
    s_add_u32 s59, s59, 28672
    s_mov_b32 m0, 142336
    buffer_load_dwordx4 v8, s[24:27], s59 offen nt lds
    s_add_u32 s59, s59, 28672
    s_mov_b32 m0, 143360
    buffer_load_dwordx4 v8, s[24:27], s59 offen nt lds
    s_add_u32 s59, s59, 28672
    s_mov_b32 m0, 144384
    buffer_load_dwordx4 v8, s[24:27], s59 offen nt lds
    s_add_u32 s59, s59, 28672
    s_mov_b32 m0, 145408
    buffer_load_dwordx4 v8, s[24:27], s59 offen nt lds
    s_add_u32 s59, s59, 28672
    s_mov_b32 m0, 146432
    buffer_load_dwordx4 v8, s[24:27], s59 offen nt lds
    s_add_u32 s59, s59, 28672
    s_mov_b32 m0, 147456
    buffer_load_dwordx4 v8, s[24:27], s59 offen nt lds
    s_add_u32 s59, s59, 28672
    s_mov_b32 m0, 148480
    buffer_load_dwordx4 v8, s[24:27], s59 offen nt lds
    s_add_u32 s59, s59, 28672
    s_mov_b32 m0, 149504
    buffer_load_dwordx4 v8, s[24:27], s59 offen nt lds
    s_add_u32 s59, s59, 28672
    s_mov_b32 m0, 150528
    buffer_load_dwordx4 v8, s[24:27], s59 offen nt lds
L_H1a:
    s_lshl3_add_u32 s20, s7, s4
    s_cmp_lt_u32 s20, 14
    s_cselect_b32 s22, 1, 0
    s_cbranch_scc0 L_H1b
    s_mov_b32 s24, s48
    s_and_b32 s25, s49, 0xffff
    s_mov_b32 s26, 0x1c0000
    s_mov_b32 s27, 0x20000
    s_lshl_b32 s58, s20, 17
    s_lshl_b32 s59, s6, 7
    s_add_u32 s59, s58, s59
L_wt4:
    s_sleep 1
    s_memrealtime s[90:91]
    s_waitcnt lgkmcnt(0)
    s_sub_u32 s90, s90, s96
    s_cmp_lt_u32 s90, 265
    s_cbranch_scc1 L_wt4
    buffer_load_dwordx4 a[0:3], v15, s[24:27], s59 offen nt
    s_add_u32 s59, s59, 8192
    buffer_load_dwordx4 a[4:7], v15, s[24:27], s59 offen nt
    s_add_u32 s59, s59, 8192
    buffer_load_dwordx4 a[8:11], v15, s[24:27], s59 offen nt
    s_add_u32 s59, s59, 8192
    buffer_load_dwordx4 a[12:15], v15, s[24:27], s59 offen nt
    s_add_u32 s59, s59, 8192
    buffer_load_dwordx4 a[16:19], v15, s[24:27], s59 offen nt
    s_add_u32 s59, s59, 8192
    buffer_load_dwordx4 a[20:23], v15, s[24:27], s59 offen nt
    s_add_u32 s59, s59, 8192
    buffer_load_dwordx4 a[24:27], v15, s[24:27], s59 offen nt
    s_add_u32 s59, s59, 8192
    buffer_load_dwordx4 a[28:31], v15, s[24:27], s59 offen nt
    s_add_u32 s59, s59, 8192
    buffer_load_dwordx4 a[32:35], v15, s[24:27], s59 offen nt
    s_add_u32 s59, s59, 8192
    buffer_load_dwordx4 a[36:39], v15, s[24:27], s59 offen nt
    s_add_u32 s59, s59, 8192
    buffer_load_dwordx4 a[40:43], v15, s[24:27], s59 offen nt
    s_add_u32 s59, s59, 8192
    buffer_load_dwordx4 a[44:47], v15, s[24:27], s59 offen nt
    s_add_u32 s59, s59, 8192
    buffer_load_dwordx4 a[48:51], v15, s[24:27], s59 offen nt
    s_add_u32 s59, s59, 8192
    buffer_load_dwordx4 a[52:55], v15, s[24:27], s59 offen nt
    s_add_u32 s59, s59, 8192
    buffer_load_dwordx4 a[56:59], v15, s[24:27], s59 offen nt
    s_add_u32 s59, s59, 8192
    buffer_load_dwordx4 a[60:63], v15, s[24:27], s59 offen nt
L_H1b:
    v_mov_b32 v12, 133432
    s_movk_i32 s70, 0x800
L_lv3:
    ds_read_b32 v13, v12
    s_waitcnt lgkmcnt(0)
    v_readfirstlane_b32 s31, v13
    s_sub_u32 s70, s70, 1
    s_cselect_b32 s31, 2, s31
    s_cmp_eq_u32 s31, 0
    s_cbranch_scc1 L_lv3
    s_cmp_eq_u32 s31, 1
    s_cbranch_scc1 L_sl4
    buffer_store_dwordx4 v[48:51], v10, s[16:19], s66 offen offset:0 sc1
    buffer_store_dwordx4 v[52:55], v10, s[16:19], s66 offen offset:128 sc1
    s_branch L_se4
L_sl4:
    buffer_store_dwordx4 v[48:51], v10, s[16:19], s66 offen offset:0
    buffer_store_dwordx4 v[52:55], v10, s[16:19], s66 offen offset:128
L_se4:
    s_waitcnt vmcnt(0)
    s_cmp_ge_u32 s23, 56
    s_cbranch_scc1 L_H1c
    s_lshl2_add_u32 s58, s23, s7
    s_lshl_b32 s58, s58, 11
    s_add_u32 s58, s58, 3670016
    ds_read_b64_tr_b16 v[48:49], v9 offset:0
    ds_read_b64_tr_b16 v[50:51], v9 offset:512
    ds_read_b64_tr_b16 v[52:53], v9 offset:32
    ds_read_b64_tr_b16 v[54:55], v9 offset:544
    ds_read_b64_tr_b16 v[56:57], v9 offset:64
    ds_read_b64_tr_b16 v[58:59], v9 offset:576
    ds_read_b64_tr_b16 v[60:61], v9 offset:96
    ds_read_b64_tr_b16 v[62:63], v9 offset:608
    s_waitcnt lgkmcnt(6)
    v_mfma_f32_16x16x32_bf16 v[32:35], v[48:51], v[16:19], 0
    s_waitcnt lgkmcnt(4)
    v_mfma_f32_16x16x32_bf16 v[36:39], v[52:55], v[16:19], 0
    s_waitcnt lgkmcnt(2)
    v_mfma_f32_16x16x32_bf16 v[40:43], v[56:59], v[16:19], 0
    s_waitcnt lgkmcnt(0)
    v_mfma_f32_16x16x32_bf16 v[44:47], v[60:63], v[16:19], 0
    ds_read_b64_tr_b16 v[64:65], v9 offset:4096
    ds_read_b64_tr_b16 v[66:67], v9 offset:4608
    ds_read_b64_tr_b16 v[68:69], v9 offset:4128
    ds_read_b64_tr_b16 v[70:71], v9 offset:4640
    ds_read_b64_tr_b16 v[72:73], v9 offset:4160
    ds_read_b64_tr_b16 v[74:75], v9 offset:4672
    ds_read_b64_tr_b16 v[76:77], v9 offset:4192
    ds_read_b64_tr_b16 v[78:79], v9 offset:4704
    s_waitcnt lgkmcnt(6)
    v_mfma_f32_16x16x32_bf16 v[32:35], v[64:67], v[20:23], v[32:35]
    s_waitcnt lgkmcnt(4)
    v_mfma_f32_16x16x32_bf16 v[36:39], v[68:71], v[20:23], v[36:39]
    s_waitcnt lgkmcnt(2)
    v_mfma_f32_16x16x32_bf16 v[40:43], v[72:75], v[20:23], v[40:43]
    s_waitcnt lgkmcnt(0)
    v_mfma_f32_16x16x32_bf16 v[44:47], v[76:79], v[20:23], v[44:47]
    ds_read_b64_tr_b16 v[48:49], v9 offset:8192
    ds_read_b64_tr_b16 v[50:51], v9 offset:8704
    ds_read_b64_tr_b16 v[52:53], v9 offset:8224
    ds_read_b64_tr_b16 v[54:55], v9 offset:8736
    ds_read_b64_tr_b16 v[56:57], v9 offset:8256
    ds_read_b64_tr_b16 v[58:59], v9 offset:8768
    ds_read_b64_tr_b16 v[60:61], v9 offset:8288
    ds_read_b64_tr_b16 v[62:63], v9 offset:8800
    s_waitcnt lgkmcnt(6)
    v_mfma_f32_16x16x32_bf16 v[32:35], v[48:51], v[24:27], v[32:35]
    s_waitcnt lgkmcnt(4)
    v_mfma_f32_16x16x32_bf16 v[36:39], v[52:55], v[24:27], v[36:39]
    s_waitcnt lgkmcnt(2)
    v_mfma_f32_16x16x32_bf16 v[40:43], v[56:59], v[24:27], v[40:43]
    s_waitcnt lgkmcnt(0)
    v_mfma_f32_16x16x32_bf16 v[44:47], v[60:63], v[24:27], v[44:47]
    ds_read_b64_tr_b16 v[64:65], v9 offset:12288
    ds_read_b64_tr_b16 v[66:67], v9 offset:12800
    ds_read_b64_tr_b16 v[68:69], v9 offset:12320
    ds_read_b64_tr_b16 v[70:71], v9 offset:12832
    ds_read_b64_tr_b16 v[72:73], v9 offset:12352
    ds_read_b64_tr_b16 v[74:75], v9 offset:12864
    ds_read_b64_tr_b16 v[76:77], v9 offset:12384
    ds_read_b64_tr_b16 v[78:79], v9 offset:12896
    s_waitcnt lgkmcnt(6)
    v_mfma_f32_16x16x32_bf16 v[32:35], v[64:67], v[28:31], v[32:35]
    s_waitcnt lgkmcnt(4)
    v_mfma_f32_16x16x32_bf16 v[36:39], v[68:71], v[28:31], v[36:39]
    s_waitcnt lgkmcnt(2)
    v_mfma_f32_16x16x32_bf16 v[40:43], v[72:75], v[28:31], v[40:43]
    s_waitcnt lgkmcnt(0)
    v_mfma_f32_16x16x32_bf16 v[44:47], v[76:79], v[28:31], v[44:47]
    s_nop 7
    s_nop 0
    v_cndmask_b32 v48, v32, v36, s[62:63]
    v_cndmask_b32 v49, v33, v37, s[62:63]
    v_cndmask_b32 v50, v34, v38, s[62:63]
    v_cndmask_b32 v51, v35, v39, s[62:63]
    v_perm_b32 v48, v48, v126, s92
    v_perm_b32 v49, v49, v126, s93
    v_perm_b32 v50, v50, v126, s94
    v_perm_b32 v51, v51, v126, s95
    v_cndmask_b32 v52, v40, v44, s[62:63]
    v_cndmask_b32 v53, v41, v45, s[62:63]
    v_cndmask_b32 v54, v42, v46, s[62:63]
    v_cndmask_b32 v55, v43, v47, s[62:63]
    v_perm_b32 v52, v52, v126, s92
    v_perm_b32 v53, v53, v126, s93
    v_perm_b32 v54, v54, v126, s94
    v_perm_b32 v55, v55, v126, s95
    s_cmp_eq_u32 s31, 1
    s_cbranch_scc1 L_sl5
    buffer_store_dwordx4 v[48:51], v11, s[16:19], s58 offen offset:0 sc1
    buffer_store_dwordx4 v[52:55], v11, s[16:19], s58 offen offset:128 sc1
    s_branch L_se5
L_sl5:
    buffer_store_dwordx4 v[48:51], v11, s[16:19], s58 offen offset:0
    buffer_store_dwordx4 v[52:55], v11, s[16:19], s58 offen offset:128
L_se5:
L_H1c:
    s_cmp_eq_u32 s22, 0
    s_cbranch_scc1 L_H1wo2
    ds_write_b128 v14, a[0:3] offset:0
    ds_write_b128 v14, a[4:7] offset:1024
    ds_write_b128 v14, a[8:11] offset:2048
    ds_write_b128 v14, a[12:15] offset:3072
    ds_write_b128 v14, a[16:19] offset:4096
    ds_write_b128 v14, a[20:23] offset:5120
    ds_write_b128 v14, a[24:27] offset:6144
    ds_write_b128 v14, a[28:31] offset:7168
    s_waitcnt lgkmcnt(0)
    ds_write_b128 v14, a[32:35] offset:8192
    ds_write_b128 v14, a[36:39] offset:9216
    ds_write_b128 v14, a[40:43] offset:10240
    ds_write_b128 v14, a[44:47] offset:11264
    ds_write_b128 v14, a[48:51] offset:12288
    ds_write_b128 v14, a[52:55] offset:13312
    ds_write_b128 v14, a[56:59] offset:14336
    ds_write_b128 v14, a[60:63] offset:15360
    s_lshl_b32 s20, s20, 12
    s_add_u32 s20, s20, 458752
    v_lshl_add_u32 v13, v3, 8, v5
    s_mov_b32 s21, 0x07060302
    v_mov_b32 v16, 0
    v_mov_b32 v17, 0
    v_mov_b32 v18, 0
    v_mov_b32 v19, 0
    v_mov_b32 v20, 0
    v_mov_b32 v21, 0
    v_mov_b32 v22, 0
    v_mov_b32 v23, 0
    v_mov_b32 v24, 0
    v_mov_b32 v25, 0
    v_mov_b32 v26, 0
    v_mov_b32 v27, 0
    v_mov_b32 v28, 0
    v_mov_b32 v29, 0
    v_mov_b32 v30, 0
    v_mov_b32 v31, 0
L_wt5:
    s_sleep 16
    s_memrealtime s[90:91]
    s_waitcnt lgkmcnt(0)
    s_sub_u32 s90, s90, s96
    s_cmp_lt_u32 s90, 1300
    s_cbranch_scc1 L_wt5
    s_mov_b64 exec, s[62:63]
    s_mov_b32 s70, 0x8000
L_hpn:
    buffer_load_dwordx4 v[64:67], v13, s[16:19], s20 offen offset:0 nt
    buffer_load_dwordx4 v[68:71], v13, s[16:19], s20 offen offset:128 nt
    buffer_load_dwordx4 v[72:75], v13, s[16:19], s20 offen offset:1024 nt
    buffer_load_dwordx4 v[76:79], v13, s[16:19], s20 offen offset:1152 nt
    buffer_load_dwordx4 v[80:83], v13, s[16:19], s20 offen offset:2048 nt
    buffer_load_dwordx4 v[84:87], v13, s[16:19], s20 offen offset:2176 nt
    buffer_load_dwordx4 v[88:91], v13, s[16:19], s20 offen offset:3072 nt
    buffer_load_dwordx4 v[92:95], v13, s[16:19], s20 offen offset:3200 nt
    s_branch L_hpc
L_hp:
    buffer_load_dwordx4 v[64:67], v13, s[16:19], s20 offen offset:0 sc1
    buffer_load_dwordx4 v[68:71], v13, s[16:19], s20 offen offset:128 sc1
    buffer_load_dwordx4 v[72:75], v13, s[16:19], s20 offen offset:1024 sc1
    buffer_load_dwordx4 v[76:79], v13, s[16:19], s20 offen offset:1152 sc1
    buffer_load_dwordx4 v[80:83], v13, s[16:19], s20 offen offset:2048 sc1
    buffer_load_dwordx4 v[84:87], v13, s[16:19], s20 offen offset:2176 sc1
    buffer_load_dwordx4 v[88:91], v13, s[16:19], s20 offen offset:3072 sc1
    buffer_load_dwordx4 v[92:95], v13, s[16:19], s20 offen offset:3200 sc1
L_hpc:
    s_sub_u32 s70, s70, 1
    s_waitcnt vmcnt(0)
    v_perm_b32 v11, v65, v64, s64
    v_perm_b32 v12, v67, v66, s65
    v_or_b32 v10, v11, v12
    v_xor_b32 v10, v126, v10
    v_perm_b32 v11, v69, v68, s64
    v_perm_b32 v12, v71, v70, s65
    v_or_b32 v11, v11, v12
    v_xor_b32 v11, v126, v11
    v_or_b32 v10, v10, v11
    v_perm_b32 v11, v73, v72, s64
    v_perm_b32 v12, v75, v74, s65
    v_or_b32 v11, v11, v12
    v_xor_b32 v11, v126, v11
    v_or_b32 v10, v10, v11
    v_perm_b32 v11, v77, v76, s64
    v_perm_b32 v12, v79, v78, s65
    v_or_b32 v11, v11, v12
    v_xor_b32 v11, v126, v11
    v_or_b32 v10, v10, v11
    v_perm_b32 v11, v81, v80, s64
    v_perm_b32 v12, v83, v82, s65
    v_or_b32 v11, v11, v12
    v_xor_b32 v11, v126, v11
    v_or_b32 v10, v10, v11
    v_perm_b32 v11, v85, v84, s64
    v_perm_b32 v12, v87, v86, s65
    v_or_b32 v11, v11, v12
    v_xor_b32 v11, v126, v11
    v_or_b32 v10, v10, v11
    v_perm_b32 v11, v89, v88, s64
    v_perm_b32 v12, v91, v90, s65
    v_or_b32 v11, v11, v12
    v_xor_b32 v11, v126, v11
    v_or_b32 v10, v10, v11
    v_perm_b32 v11, v93, v92, s64
    v_perm_b32 v12, v95, v94, s65
    v_or_b32 v11, v11, v12
    v_xor_b32 v11, v126, v11
    v_or_b32 v10, v10, v11
    v_cmp_ne_u32 vcc, 0, v10
    s_cbranch_vccz L_hok
    s_sleep 64
    s_bitcmp0_b32 s70, 0
    s_cbranch_scc1 L_hpn
    s_cmp_gt_u32 s70, 1
    s_cbranch_scc1 L_hp
L_hok:
    v_perm_b32 v16, v65, v64, s21
    v_perm_b32 v17, v67, v66, s21
    v_perm_b32 v18, v69, v68, s21
    v_perm_b32 v19, v71, v70, s21
    v_perm_b32 v20, v73, v72, s21
    v_perm_b32 v21, v75, v74, s21
    v_perm_b32 v22, v77, v76, s21
    v_perm_b32 v23, v79, v78, s21
    v_perm_b32 v24, v81, v80, s21
    v_perm_b32 v25, v83, v82, s21
    v_perm_b32 v26, v85, v84, s21
    v_perm_b32 v27, v87, v86, s21
    v_perm_b32 v28, v89, v88, s21
    v_perm_b32 v29, v91, v90, s21
    v_perm_b32 v30, v93, v92, s21
    v_perm_b32 v31, v95, v94, s21
    s_mov_b64 exec, -1
    ds_read_b64_tr_b16 v[48:49], v9 offset:0
    ds_read_b64_tr_b16 v[50:51], v9 offset:512
    ds_read_b64_tr_b16 v[52:53], v9 offset:4096
    ds_read_b64_tr_b16 v[54:55], v9 offset:4608
    ds_read_b64_tr_b16 v[56:57], v9 offset:8192
    ds_read_b64_tr_b16 v[58:59], v9 offset:8704
    ds_read_b64_tr_b16 v[60:61], v9 offset:12288
    ds_read_b64_tr_b16 v[62:63], v9 offset:12800
    ds_read_b64_tr_b16 v[64:65], v9 offset:32
    ds_read_b64_tr_b16 v[66:67], v9 offset:544
    ds_read_b64_tr_b16 v[68:69], v9 offset:4128
    ds_read_b64_tr_b16 v[70:71], v9 offset:4640
    ds_read_b64_tr_b16 v[72:73], v9 offset:8224
    ds_read_b64_tr_b16 v[74:75], v9 offset:8736
    ds_read_b64_tr_b16 v[76:77], v9 offset:12320
    ds_read_b64_tr_b16 v[78:79], v9 offset:12832
    s_waitcnt lgkmcnt(0)
    ds_read_b64_tr_b16 v[80:81], v9 offset:64
    ds_read_b64_tr_b16 v[82:83], v9 offset:576
    ds_read_b64_tr_b16 v[84:85], v9 offset:4160
    ds_read_b64_tr_b16 v[86:87], v9 offset:4672
    ds_read_b64_tr_b16 v[88:89], v9 offset:8256
    ds_read_b64_tr_b16 v[90:91], v9 offset:8768
    ds_read_b64_tr_b16 v[92:93], v9 offset:12352
    ds_read_b64_tr_b16 v[94:95], v9 offset:12864
    ds_read_b64_tr_b16 v[96:97], v9 offset:96
    ds_read_b64_tr_b16 v[98:99], v9 offset:608
    ds_read_b64_tr_b16 v[100:101], v9 offset:4192
    ds_read_b64_tr_b16 v[102:103], v9 offset:4704
    ds_read_b64_tr_b16 v[104:105], v9 offset:8288
    ds_read_b64_tr_b16 v[106:107], v9 offset:8800
    ds_read_b64_tr_b16 v[108:109], v9 offset:12384
    ds_read_b64_tr_b16 v[110:111], v9 offset:12896
    v_lshlrev_b32 v10, 2, v5
    v_lshl_add_u32 v10, v3, 4, v10
    v_add_u32 v10, 159744, v10
    s_waitcnt lgkmcnt(0)
    v_mfma_f32_16x16x32_bf16 v[32:35], v[48:51], v[16:19], 0
    v_mfma_f32_16x16x32_bf16 v[32:35], v[52:55], v[20:23], v[32:35]
    v_mfma_f32_16x16x32_bf16 v[32:35], v[56:59], v[24:27], v[32:35]
    v_mfma_f32_16x16x32_bf16 v[32:35], v[60:63], v[28:31], v[32:35]
    v_mfma_f32_16x16x32_bf16 v[36:39], v[64:67], v[16:19], 0
    v_mfma_f32_16x16x32_bf16 v[36:39], v[68:71], v[20:23], v[36:39]
    v_mfma_f32_16x16x32_bf16 v[36:39], v[72:75], v[24:27], v[36:39]
    v_mfma_f32_16x16x32_bf16 v[36:39], v[76:79], v[28:31], v[36:39]
    v_mfma_f32_16x16x32_bf16 v[40:43], v[80:83], v[16:19], 0
    v_mfma_f32_16x16x32_bf16 v[40:43], v[84:87], v[20:23], v[40:43]
    v_mfma_f32_16x16x32_bf16 v[40:43], v[88:91], v[24:27], v[40:43]
    v_mfma_f32_16x16x32_bf16 v[40:43], v[92:95], v[28:31], v[40:43]
    v_mfma_f32_16x16x32_bf16 v[44:47], v[96:99], v[16:19], 0
    v_mfma_f32_16x16x32_bf16 v[44:47], v[100:103], v[20:23], v[44:47]
    v_mfma_f32_16x16x32_bf16 v[44:47], v[104:107], v[24:27], v[44:47]
    v_mfma_f32_16x16x32_bf16 v[44:47], v[108:111], v[28:31], v[44:47]
    s_nop 7
    s_nop 3
    s_mov_b64 exec, s[62:63]
    ds_write_b128 v10, v[32:35] offset:0
    ds_write_b128 v10, v[36:39] offset:512
    ds_write_b128 v10, v[40:43] offset:1024
    ds_write_b128 v10, v[44:47] offset:1536
    s_mov_b64 exec, -1
L_H1wo2:
    v_mov_b32 v10, 133396
    v_mov_b32 v11, 1
    ds_write_b32 v10, v11
    s_waitcnt vmcnt(0) lgkmcnt(0)
L_Hbar2:
    s_and_b32 s21, s3, 1
    s_lshl_b32 s22, s21, 10
    s_add_u32 s48, s22, 151552
    v_lshl_add_u32 v116, v0, 4, s48
    v_lshrrev_b32 v120, 5, v0
    s_mul_i32 s48, s21, 1152
    s_add_u32 s48, s48, 28672
    v_lshl_add_u32 v116, v0, 4, s48
    v_lshl_add_u32 v116, v120, 6, v116
    v_add_u32 v119, 0x10000, v116
    v_lshlrev_b32 v120, 4, v120
    s_lshl_b32 s21, s21, 5
    s_add_u32 s21, s21, 133504
    v_add_u32 v120, s21, v120
    s_lshl2_add_u32 s48, s89, s7
    s_lshl_b32 s48, s48, 11
    s_add_u32 s48, s48, s22
    s_add_u32 s48, s48, 524288
    v_lshlrev_b32 v121, 4, v0
    s_lshl_b32 s58, s3, 5
    s_add_u32 s58, s58, 135168
    v_add_u32 v9, s58, v6
    v_and_b32 v10, 1, v3
    v_bfe_u32 v11, v0, 2, 2
    v_xor_b32 v10, v10, v11
    v_lshlrev_b32 v10, 5, v10
    v_xor_b32 v9, v9, v10
    s_mov_b32 s20, 0x11333333
    s_lshl2_add_u32 s22, s4, s7
    s_bitcmp1_b32 s20, s22
    s_cselect_b32 s98, -1, 0x00ff00ff
    s_mov_b32 s99, s98
    v_lshlrev_b32 v80, 2, v5
    v_lshl_add_u32 v80, v3, 4, v80
    s_lshl_b32 s20, s3, 9
    s_add_u32 s20, s20, 159744
    v_add_u32 v80, s20, v80
    v_mov_b32 v83, 133120
    s_and_b32 vcc_lo, s98, 0xff00ff00
    s_mov_b32 vcc_hi, vcc_lo
    v_cndmask_b32 v80, v83, v80, vcc
    v_mul_u32_u24 v81, 17, v5
    v_add_u32 v81, 16, v81
    v_cmp_gt_u32 vcc, 8, v2
    s_nop 1
    v_cndmask_b32 v81, v83, v81, vcc
    v_lshl_add_u32 v81, v3, 4, v81
    v_lshlrev_b32 v82, 6, v2
    v_lshl_add_u32 v82, v3, 4, v82
    s_lshl2_add_u32 s49, s6, s3
    s_lshl_b32 s49, s49, 5
    s_add_u32 s49, s49, s22
    s_lshl_b32 s49, s49, 10
    s_add_u32 s49, s49, 2097152
    s_mov_b32 s20, 0x11333333
    v_lshrrev_b32 v89, v4, s20
    v_bfe_u32 v90, v0, 2, 1
    v_mov_b32 v91, 0
    v_lshlrev_b32 v93, 10, v4
    v_lshl_add_u32 v93, v7, 4, v93
    v_lshl_add_u32 v93, v90, 9, v93
    s_lshl_b32 s21, s6, 6
    v_add_u32 v93, s21, v93
    v_bfe_u32 v92, v89, 0, 1
    v_cmp_ge_u32 s[40:41], v92, v90
    v_add_u32 v112, 0, v93
    v_perm_b32 v96, v91, v126, s92
    v_perm_b32 v97, v91, v126, s93
    v_perm_b32 v98, v91, v126, s94
    v_perm_b32 v99, v91, v126, s95
    v_bfe_u32 v92, v89, 8, 1
    v_cmp_ge_u32 s[42:43], v92, v90
    v_add_u32 v113, 8192, v93
    v_perm_b32 v100, v91, v126, s92
    v_perm_b32 v101, v91, v126, s93
    v_perm_b32 v102, v91, v126, s94
    v_perm_b32 v103, v91, v126, s95
    v_bfe_u32 v92, v89, 16, 1
    v_cmp_ge_u32 s[44:45], v92, v90
    v_add_u32 v114, 16384, v93
    v_perm_b32 v104, v91, v126, s92
    v_perm_b32 v105, v91, v126, s93
    v_perm_b32 v106, v91, v126, s94
    v_perm_b32 v107, v91, v126, s95
    v_bfe_u32 v92, v89, 24, 1
    v_cmp_ge_u32 s[46:47], v92, v90
    v_add_u32 v115, 24576, v93
    v_perm_b32 v108, v91, v126, s92
    v_perm_b32 v109, v91, v126, s93
    v_perm_b32 v110, v91, v126, s94
    v_perm_b32 v111, v91, v126, s95
    s_lshl3_add_u32 s58, s3, s4
    s_lshl_b32 s58, s58, 13
    s_lshl_b32 s60, s7, 9
    s_add_u32 s58, s58, s60
    s_add_u32 s60, s58, 524288
    s_add_u32 s61, s58, 528384
    v_lshrrev_b32 v50, 5, v0
    v_and_b32 v51, 31, v0
    v_lshlrev_b32 v48, 11, v50
    v_lshl_add_u32 v48, v51, 4, v48
    s_mul_i32 s58, s3, 272
    s_add_u32 s58, s58, 16
    v_lshl_add_u32 v50, v51, 3, s58
    s_mov_b64 s[66:67], -1
    s_mov_b64 s[68:69], -1
    s_mov_b32 s70, 0x40000
    v_add_u32 v49, 0x80000, v48
    v_add_u32 v122, 0x80000, v121
    s_cmp_lt_u32 s3, 2
    s_cbranch_scc1 L_nopt
L_wt6:
    s_sleep 16
    s_memrealtime s[90:91]
    s_waitcnt lgkmcnt(0)
    s_sub_u32 s90, s90, s96
    s_cmp_lt_u32 s90, 3300
    s_cbranch_scc1 L_wt6
    v_not_b32 v16, v126
    v_not_b32 v17, v126
    v_not_b32 v18, v126
    v_not_b32 v19, v126
    v_mov_b32 v20, 133432
    ds_read_b32 v21, v20
    s_waitcnt lgkmcnt(0)
    v_readfirstlane_b32 s31, v21
    s_cmp_eq_u32 s31, 1
    s_cselect_b64 s[30:31], 0, -1
L_nopt:
    s_cmp_lt_u32 s3, 2
    s_barrier
    s_cbranch_scc1 L_nocomb
L_dry:
    ds_read_b128 v[24:27], v120
    ds_read_b128 v[56:59], v116 offset:0
    ds_read_b128 v[60:63], v116 offset:32768
    ds_read_b128 v[64:67], v119 offset:0
    ds_read_b128 v[68:71], v119 offset:32768
    s_waitcnt lgkmcnt(2)
    v_mul_f32 v16, v24, v56
    v_mul_f32 v17, v24, v57
    v_mul_f32 v18, v24, v58
    v_mul_f32 v19, v24, v59
    v_fmac_f32 v16, v25, v60
    v_fmac_f32 v17, v25, v61
    v_fmac_f32 v18, v25, v62
    v_fmac_f32 v19, v25, v63
    s_waitcnt lgkmcnt(0)
    v_fmac_f32 v16, v26, v64
    v_fmac_f32 v17, v26, v65
    v_fmac_f32 v18, v26, v66
    v_fmac_f32 v19, v26, v67
    v_fmac_f32 v16, v27, v68
    v_fmac_f32 v17, v27, v69
    v_fmac_f32 v18, v27, v70
    v_fmac_f32 v19, v27, v71
    v_perm_b32 v16, v16, v126, s92
    v_perm_b32 v17, v17, v126, s93
    v_perm_b32 v18, v18, v126, s94
    v_perm_b32 v19, v19, v126, s95
    buffer_store_dwordx4 v[16:19], v122, s[16:19], s48 offen
    s_mov_b64 exec, s[30:31]
    buffer_store_dwordx4 v[16:19], v121, s[16:19], s48 offen sc1
    s_mov_b64 exec, -1
L_nocomb:
    ds_read_b128 v[84:87], v80
    s_cbranch_scc1 L_gslp
    s_branch L_pollr
L_gather:
    s_lshl3_add_u32 s58, s3, s4
    s_lshl_b32 s58, s58, 13
    s_lshl_b32 s60, s7, 9
    s_add_u32 s58, s58, s60
    s_add_u32 s60, s58, 524288
    s_add_u32 s61, s58, 528384
    v_lshrrev_b32 v50, 5, v0
    v_and_b32 v51, 31, v0
    v_lshlrev_b32 v48, 11, v50
    v_lshl_add_u32 v48, v51, 4, v48
    s_mul_i32 s58, s3, 272
    s_add_u32 s58, s58, 16
    v_lshl_add_u32 v50, v51, 3, s58
    s_mov_b64 s[66:67], -1
    s_mov_b64 s[68:69], -1
    s_mov_b32 s70, 0x40000
    v_add_u32 v49, 0x80000, v48
L_gslp:
    s_sleep 4
L_pollr:
    s_mov_b64 exec, s[66:67]
    buffer_load_dwordx4 v[56:59], v49, s[16:19], s60 offen nt
    s_mov_b64 exec, s[68:69]
    buffer_load_dwordx4 v[60:63], v49, s[16:19], s61 offen nt
    s_branch L_pollrc
L_pollr2:
    s_mov_b64 exec, s[66:67]
    buffer_load_dwordx4 v[56:59], v48, s[16:19], s60 offen sc1
    s_mov_b64 exec, s[68:69]
    buffer_load_dwordx4 v[60:63], v48, s[16:19], s61 offen sc1
L_pollrc:
    s_mov_b64 exec, -1
    s_waitcnt vmcnt(0)
    v_perm_b32 v52, v57, v56, s64
    v_perm_b32 v53, v59, v58, s65
    v_perm_b32 v54, v61, v60, s64
    v_perm_b32 v55, v63, v62, s65
    v_or_b32 v52, v52, v53
    v_or_b32 v54, v54, v55
    v_cmp_ne_u32 s[66:67], v126, v52
    v_cmp_ne_u32 s[68:69], v126, v54
    v_add_f32 v64, v56, v60
    v_add_f32 v65, v57, v61
    v_add_f32 v66, v58, v62
    v_add_f32 v67, v59, v63
    s_or_b64 vcc, s[66:67], s[68:69]
    s_cbranch_scc0 L_rok
    s_sleep 1
    s_sub_u32 s70, s70, 1
    s_and_b32 s58, s70, 7
    s_cbranch_scc1 L_pollr
    s_cmp_lg_u32 s70, 0
    s_cbranch_scc1 L_pollr2
L_rok:
    v_permlane32_swap_b32 v64, v66
    v_permlane32_swap_b32 v65, v67
    v_lshrrev_b32 v53, 3, v0
    v_add_f32 v64, v64, v66
    v_add_f32 v65, v65, v67
    v_and_or_b32 v50, v53, 4, v50
    v_cvt_pk_bf16_f32 v52, v64, v65
    ds_write_b32 v50, v52
    s_waitcnt lgkmcnt(0)
    s_barrier
    s_cmp_ge_u32 s3, 4
    s_cbranch_scc1 L_fin
    ds_read_b64_tr_b16 v[32:33], v9 offset:0
    ds_read_b64_tr_b16 v[34:35], v9 offset:512
    ds_read_b128 v[48:51], v81 offset:0
    ds_read_b64_tr_b16 v[36:37], v9 offset:4096
    ds_read_b64_tr_b16 v[38:39], v9 offset:4608
    ds_read_b128 v[52:55], v81 offset:64
    ds_read_b64_tr_b16 v[40:41], v9 offset:8192
    ds_read_b64_tr_b16 v[42:43], v9 offset:8704
    ds_read_b128 v[56:59], v81 offset:128
    ds_read_b64_tr_b16 v[44:45], v9 offset:12288
    ds_read_b64_tr_b16 v[46:47], v9 offset:12800
    ds_read_b128 v[60:63], v81 offset:192
    s_waitcnt lgkmcnt(9)
    v_mfma_f32_16x16x32_bf16 v[84:87], v[32:35], v[48:51], v[84:87]
    s_waitcnt lgkmcnt(6)
    v_mfma_f32_16x16x32_bf16 v[84:87], v[36:39], v[52:55], v[84:87]
    s_waitcnt lgkmcnt(3)
    v_mfma_f32_16x16x32_bf16 v[84:87], v[40:43], v[56:59], v[84:87]
    s_waitcnt lgkmcnt(0)
    v_mfma_f32_16x16x32_bf16 v[84:87], v[44:47], v[60:63], v[84:87]
    s_mov_b64 exec, s[98:99]
    s_nop 7
    s_nop 2
    v_perm_b32 v64, v84, v126, s92
    v_perm_b32 v65, v85, v126, s93
    v_perm_b32 v66, v86, v126, s94
    v_perm_b32 v67, v87, v126, s95
    buffer_store_dwordx4 v[64:67], v82, s[16:19], s49 offen sc1
    s_mov_b64 exec, -1
    s_cmp_lg_u32 s3, 0
    s_cbranch_scc1 L_fin
    s_mov_b32 s24, s52
    s_and_b32 s25, s53, 0xffff
    s_mov_b32 s26, 0x2000
    s_mov_b32 s27, 0x20000
    s_lshl2_add_u32 s59, s4, s7
    s_lshl_b32 s59, s59, 15
    s_add_u32 s59, s59, 2097152
    s_mov_b32 s70, 0x40000
    s_lshl_b32 s58, s6, 10
    s_lshl_b32 s20, s4, 7
    s_add_u32 s58, s58, s20
    s_lshl_b32 s20, s7, 5
    s_add_u32 s58, s58, s20
    v_cmp_eq_u32 vcc, 0, v90
    v_lshrrev_b32 v124, 5, v0
    v_bfe_u32 v125, v0, 4, 1
    v_cndmask_b32 v123, v118, v117, vcc
    v_lshl_add_u32 v124, v125, 1, v124
    v_lshl_add_u32 v124, v7, 2, v124
    v_lshlrev_b32 v124, 1, v124
    s_sleep 14
L_pollia:
    s_mov_b64 exec, s[40:41]
    buffer_load_dwordx4 v[96:99], v112, s[16:19], s59 offen sc1 nt
    s_mov_b64 exec, s[42:43]
    buffer_load_dwordx4 v[100:103], v113, s[16:19], s59 offen sc1 nt
    s_mov_b64 exec, s[44:45]
    buffer_load_dwordx4 v[104:107], v114, s[16:19], s59 offen sc1 nt
    s_mov_b64 exec, s[46:47]
    buffer_load_dwordx4 v[108:111], v115, s[16:19], s59 offen sc1 nt
    s_mov_b64 exec, -1
    s_waitcnt vmcnt(0)
    v_perm_b32 v25, v97, v96, s64
    v_perm_b32 v26, v99, v98, s65
    v_or_b32 v24, v25, v26
    v_xor_b32 v24, v126, v24
    v_perm_b32 v25, v101, v100, s64
    v_perm_b32 v26, v103, v102, s65
    v_or_b32 v25, v25, v26
    v_xor_b32 v25, v126, v25
    v_or_b32 v24, v24, v25
    v_perm_b32 v25, v105, v104, s64
    v_perm_b32 v26, v107, v106, s65
    v_or_b32 v25, v25, v26
    v_xor_b32 v25, v126, v25
    v_or_b32 v24, v24, v25
    v_perm_b32 v25, v109, v108, s64
    v_perm_b32 v26, v111, v110, s65
    v_or_b32 v25, v25, v26
    v_xor_b32 v25, v126, v25
    v_or_b32 v24, v24, v25
    v_cmp_ne_u32 vcc, 0, v24
    s_cbranch_vccz L_ioka
    s_sleep 1
    s_sub_u32 s70, s70, 1
    s_cmp_lg_u32 s70, 0
    s_cbranch_scc1 L_pollia
L_ioka:
    v_add_f32 v16, v96, v100
    v_add_f32 v20, v104, v108
    v_add_f32 v17, v97, v101
    v_add_f32 v21, v105, v109
    v_add_f32 v18, v98, v102
    v_add_f32 v22, v106, v110
    v_add_f32 v19, v99, v103
    v_add_f32 v23, v107, v111
    v_add_f32 v16, v16, v20
    v_add_f32 v17, v17, v21
    v_add_f32 v18, v18, v22
    v_add_f32 v19, v19, v23
    s_nop 0
    v_permlane32_swap_b32 v16, v17
    v_permlane32_swap_b32 v18, v19
    v_add_f32 v16, v16, v17
    v_add_f32 v18, v18, v19
    s_nop 1
    v_permlane16_swap_b32 v16, v18
    v_add_f32 v16, v16, v18
    s_nop 1
    v_add_f32_dpp v17, v16, v16 row_ror:8 row_mask:0xf bank_mask:0xf
    v_cvt_pk_bf16_f32 v17, v17, v17
    v_and_b32 v17, 0xffff0000, v17
    v_mul_f32 v17, v123, v17
    v_cvt_pk_bf16_f32 v17, v17, v17
    v_and_b32 v17, 0xffff0000, v17
    s_nop 1
    v_add_f32_dpp v16, v17, v17 row_ror:4 row_mask:0xf bank_mask:0xf
    v_cvt_pk_bf16_f32 v16, v16, v16
    s_mov_b32 exec_lo, 0x000f000f
    s_mov_b32 exec_hi, 0x000f000f
    buffer_store_short v16, v124, s[24:27], s58 offen
    v_mov_b32 v8, 0
    s_cmp_lg_u32 s2, 0
    s_cbranch_scc1 L_noep
    s_mov_b64 exec, 1
    buffer_store_dword v126, v8, s[16:19], 0 offen offset:0
L_noep:
L_fin:
L_end:
    s_endpgm
.section .rodata,"a"
.p2align 6
.amdhsa_kernel gated_mix__gqa_block_cached__geglu_ffn__decode_kernel
  .amdhsa_next_free_vgpr 256
  .amdhsa_next_free_sgpr 100
  .amdhsa_accum_offset 128
  .amdhsa_group_segment_fixed_size 0
  .amdhsa_kernarg_size 104
  .amdhsa_user_sgpr_count 2
  .amdhsa_user_sgpr_kernarg_segment_ptr 1
  .amdhsa_system_sgpr_workgroup_id_x 1
.end_amdhsa_kernel
```
